```python
import torch

def _softmax(x, axis=-1):
    return torch.softmax(x, dim=axis)
def _gelu(x):
    return torch.nn.functional.gelu(x, approximate="tanh")
def _silu(x):
    return torch.nn.functional.silu(x)
def _sigmoid(x):
    return torch.sigmoid(x)
def _layernorm(x, axis=-1, eps=1e-5):
    m = x.mean(dim=axis, keepdim=True)
    v = x.var(dim=axis, keepdim=True, unbiased=False)
    return (x - m) / torch.sqrt(v + eps)
def _scatter_add(tgt, idx, src, axis=0):
    return tgt.clone().index_add_(axis, idx, src)
def _segment_sum(src, seg, n):
    out = torch.zeros((n,) + src.shape[1:], dtype=src.dtype)
    return out.index_add_(0, seg, src)
def _pad(x, pw):
    flat = tuple(v for pair in reversed(pw) for v in pair)
    return torch.nn.functional.pad(x, flat)

kernel_name = 'standalone__self_sup_conv_stem_hubert__speech'

def setup_inputs():

    _w = (lambda a: (lambda t: t.to(torch.bfloat16) if t.is_floating_point() else t)(torch.as_tensor(a)))
    B, T, D, K = 2, 1000, 512, 31
    scale = (1.0 / (K * D)) ** 0.5
    return {
        "x": _w((lambda *s: torch.randn(*s, dtype=torch.bfloat16) * 0.05)(B, T, D)),
        "w": _w((lambda *s: torch.randn(*s, dtype=torch.bfloat16) * 0.05)(K, D, D) * scale),
        "b": _w((lambda *s: torch.randn(*s, dtype=torch.bfloat16) * 0.05)(D) * 0.1),
        "gamma": _w(torch.ones((D,), dtype=float)),
        "beta": _w(torch.zeros((D,), dtype=float)),
    }

def reference(x, w, b, gamma, beta):
    B, T, D = x.shape
    K = w.shape[0]
    s = 2
    L = (T - K) // s + 1
    y = torch.einsum('blc,cd->bld', x[:, 0 : s * L : s, :], w[0])
    for i in range(1, K):
        y = y + torch.einsum('blc,cd->bld', x[:, i : i + s * L : s, :], w[i])
    y = y + b[None, None, :]
    mu = y.mean(1, keepdims=True)
    var = ((y - mu) ** 2).mean(1, keepdims=True)
    yn = (y - mu) / torch.sqrt(var + 1e-5)
    yn = yn * gamma[None, None, :] + beta[None, None, :]
    return _gelu(yn)
```

```asm
; @launch grid=(256,1,1) block=(512,1,1) lds=160256
.amdgcn_target "amdgcn-amd-amdhsa--gfx950"
.text
.globl standalone__self_sup_conv_stem_hubert__speech_kernel
.p2align 8
.p2align 12
.type standalone__self_sup_conv_stem_hubert__speech_kernel,@function
standalone__self_sup_conv_stem_hubert__speech_kernel:
    s_cmp_ge_u32 s2, 256
    s_cbranch_scc1 L_done
    s_load_dwordx16 s[4:19], s[0:1], 0
    v_lshrrev_b32 v1, 6, v0
    s_and_b32 s40, s2, 7
    v_readfirstlane_b32 s45, v1
    s_lshr_b32 s47, s2, 3
    s_and_b32 s42, s47, 1
    s_bfe_u32 s43, s2, 0x30004
    s_lshr_b32 s44, s2, 7
    v_and_b32 v1, 63, v0
    s_mul_i32 s63, s44, 1024000
    s_mov_b32 s23, 0x20000
    s_mov_b32 s26, 16252928
    s_mov_b32 s27, 0x20000
    s_lshl_b32 s65, s40, 6
    s_add_u32 s65, s65, s47
    s_lshl_b32 s65, s65, 10
    s_and_b32 s58, s45, 3
    v_and_b32 v4, 15, v1
    v_lshlrev_b32 v4, 20, v4
    v_bfe_u32 v5, v1, 5, 1
    v_lshl_or_b32 v4, v5, 19, v4
    v_bfe_u32 v5, v1, 4, 1
    v_lshl_or_b32 v4, v5, 15, v4
    v_or_b32 v7, 384, v4
    v_lshrrev_b32 v4, 3, v1
    v_and_b32 v5, 7, v1
    v_lshrrev_b32 v6, 4, v1
    v_lshlrev_b32 v5, 4, v5
    v_lshlrev_b32 v8, 5, v6
    v_xor_b32 v8, v5, v8
    v_lshl_add_u32 v3, v4, 14, v8
    v_and_b32 v6, 1, v6
    v_lshlrev_b32 v6, 5, v6
    v_xor_b32 v5, v5, v6
    s_and_b32 s48, s58, 1
    s_lshl_b32 s48, s48, 6
    v_xor_b32 v5, s48, v5
    v_lshl_add_u32 v2, v4, 10, v5
    s_add_u32 s51, s63, 1024000
    s_lshl_b32 s48, s42, 19
    s_add_u32 s63, s63, s48
    s_lshl_b32 s48, s58, 4
    s_add_u32 s48, s48, s40
    s_lshl_b32 s48, s48, 7
    s_add_u32 s63, s63, s48
    s_mul_i32 s64, s58, 4352
    s_add_u32 s64, s64, 90112
    s_mov_b32 s69, 0x20000
    s_lshl3_add_u32 s61, s40, s58
    s_lshl_b32 s61, s61, 13
    s_lshl_b32 s48, s43, 7
    s_add_u32 s61, s61, s48
    s_lshl_b32 s62, s58, 10
    s_mov_b32 s68, 0x100000
    v_and_b32 v9, 7, v1
    v_lshlrev_b32 v9, 7, v9
    v_lshrrev_b32 v10, 3, v1
    v_lshl_add_u32 v9, v10, 23, v9
    v_lshlrev_b32 v10, 11, v1
    s_lshl_b32 s49, s45, 20
    s_add_u32 s49, s49, s65
    s_lshl_b32 s50, s47, 3
    s_add_u32 s50, s50, s45
    s_lshl_b32 s50, s50, 6
    s_add_u32 s50, s50, s40
    s_lshl_b32 s50, s50, 7
    s_mov_b32 s22, 2048000
    s_mov_b64 exec, 0xf
    s_waitcnt lgkmcnt(0)
    s_mov_b64 s[20:21], s[4:5]
    s_mov_b64 s[24:25], s[6:7]
    buffer_load_dword v216, v10, s[20:23], s50 offen
    s_mov_b64 exec, 0xff
    buffer_load_dword v217, v9, s[24:27], s49 offen
    s_lshl_b32 s48, 0x1010101, s45
    s_and_b32 exec_lo, s48, 0xffffff00
    s_and_b32 exec_hi, s48, 0x0
    buffer_load_dword v214, v7, s[24:27], s65 offen
    s_mov_b64 exec, -1
    s_cmp_lt_u32 s45, 4
    s_cbranch_scc1 L_consumer
    s_mov_b32 s22, s51
    s_mov_b32 m0, s64
    s_mov_b32 s48, s63
    buffer_load_dwordx4 v3, s[20:23], s48 offen lds
    s_addk_i32 m0, 1024
    s_add_u32 s48, s48, s69
    buffer_load_dwordx4 v3, s[20:23], s48 offen lds
    s_addk_i32 m0, 1024
    s_add_u32 s48, s48, s69
    buffer_load_dwordx4 v3, s[20:23], s48 offen lds
    s_addk_i32 m0, 1024
    s_add_u32 s48, s48, s69
    buffer_load_dwordx4 v3, s[20:23], s48 offen lds
    s_addk_i32 m0, 1024
    s_add_u32 s48, s48, s69
    s_mov_b64 exec, 0xffff
    buffer_load_dwordx4 v3, s[20:23], s48 offen lds
    s_mov_b64 exec, -1
    s_mov_b32 m0, s62
    s_mov_b32 s48, s61
    buffer_load_dwordx4 v2, s[24:27], s48 offen lds
    s_addk_i32 m0, 4096
    s_add_u32 s48, s48, s68
    buffer_load_dwordx4 v2, s[24:27], s48 offen lds
    s_add_u32 m0, s64, 17408
    s_add_u32 s48, s63, 8192
    buffer_load_dwordx4 v3, s[20:23], s48 offen lds
    s_addk_i32 m0, 1024
    s_add_u32 s48, s48, s69
    buffer_load_dwordx4 v3, s[20:23], s48 offen lds
    s_addk_i32 m0, 1024
    s_add_u32 s48, s48, s69
    buffer_load_dwordx4 v3, s[20:23], s48 offen lds
    s_addk_i32 m0, 1024
    s_add_u32 s48, s48, s69
    buffer_load_dwordx4 v3, s[20:23], s48 offen lds
    s_addk_i32 m0, 1024
    s_add_u32 s48, s48, s69
    s_mov_b64 exec, 0xffff
    buffer_load_dwordx4 v3, s[20:23], s48 offen lds
    s_mov_b64 exec, -1
    s_add_u32 m0, s62, 8192
    s_add_u32 s48, s61, 2097152
    buffer_load_dwordx4 v2, s[24:27], s48 offen lds
    s_addk_i32 m0, 4096
    s_add_u32 s48, s48, s68
    buffer_load_dwordx4 v2, s[24:27], s48 offen lds
    s_waitcnt vmcnt(7)
    s_barrier
    s_add_u32 m0, s62, 16384
    s_add_u32 s48, s61, 4194304
    buffer_load_dwordx4 v2, s[24:27], s48 offen lds
    s_addk_i32 m0, 4096
    s_add_u32 s48, s48, s68
    buffer_load_dwordx4 v2, s[24:27], s48 offen lds
    s_addk_i32 m0, 4096
    s_add_u32 s48, s48, s68
    buffer_load_dwordx4 v2, s[24:27], s48 offen lds
    s_addk_i32 m0, 4096
    s_add_u32 s48, s48, s68
    buffer_load_dwordx4 v2, s[24:27], s48 offen lds
    s_waitcnt vmcnt(4)
    s_barrier
    s_add_u32 m0, s62, 32768
    s_add_u32 s48, s61, 8388608
    buffer_load_dwordx4 v2, s[24:27], s48 offen lds
    s_addk_i32 m0, 4096
    s_add_u32 s48, s48, s68
    buffer_load_dwordx4 v2, s[24:27], s48 offen lds
    s_addk_i32 m0, 4096
    s_add_u32 s48, s48, s68
    buffer_load_dwordx4 v2, s[24:27], s48 offen lds
    s_addk_i32 m0, 4096
    s_add_u32 s48, s48, s68
    buffer_load_dwordx4 v2, s[24:27], s48 offen lds
    s_add_u32 m0, s62, 49152
    s_add_u32 s48, s61, 12582912
    buffer_load_dwordx4 v2, s[24:27], s48 offen lds
    s_addk_i32 m0, 4096
    s_add_u32 s48, s48, s68
    buffer_load_dwordx4 v2, s[24:27], s48 offen lds
    s_addk_i32 m0, 4096
    s_add_u32 s48, s48, s68
    buffer_load_dwordx4 v2, s[24:27], s48 offen lds
    s_addk_i32 m0, 4096
    s_add_u32 s48, s48, s68
    buffer_load_dwordx4 v2, s[24:27], s48 offen lds
    s_cmp_eq_u32 s58, 0
    s_cbranch_scc1 L_pad0
    s_cmp_eq_u32 s58, 1
    s_cbranch_scc1 L_pad1
    s_cmp_eq_u32 s58, 2
    s_cbranch_scc1 L_pad2
    s_branch L_padE
L_hopped:
    s_waitcnt vmcnt(8)
    s_barrier
    s_mov_b32 m0, s62
    s_add_u32 s48, s61, 32768
    buffer_load_dwordx4 v2, s[24:27], s48 offen lds
    s_addk_i32 m0, 4096
    s_add_u32 s48, s48, s68
    buffer_load_dwordx4 v2, s[24:27], s48 offen lds
    s_addk_i32 m0, 4096
    s_add_u32 s48, s48, s68
    buffer_load_dwordx4 v2, s[24:27], s48 offen lds
    s_addk_i32 m0, 4096
    s_add_u32 s48, s48, s68
    buffer_load_dwordx4 v2, s[24:27], s48 offen lds
    s_add_u32 m0, s64, 34816
    s_add_u32 s48, s63, 1024
    buffer_load_dwordx4 v3, s[20:23], s48 offen lds
    s_addk_i32 m0, 1024
    s_add_u32 s48, s48, s69
    buffer_load_dwordx4 v3, s[20:23], s48 offen lds
    s_addk_i32 m0, 1024
    s_add_u32 s48, s48, s69
    buffer_load_dwordx4 v3, s[20:23], s48 offen lds
    s_addk_i32 m0, 1024
    s_add_u32 s48, s48, s69
    buffer_load_dwordx4 v3, s[20:23], s48 offen lds
    s_addk_i32 m0, 1024
    s_add_u32 s48, s48, s69
    s_mov_b64 exec, 0xffff
    buffer_load_dwordx4 v3, s[20:23], s48 offen lds
    s_mov_b64 exec, -1
    s_waitcnt vmcnt(13)
    s_barrier
    s_add_u32 m0, s62, 16384
    s_add_u32 s48, s61, 4227072
    buffer_load_dwordx4 v2, s[24:27], s48 offen lds
    s_addk_i32 m0, 4096
    s_add_u32 s48, s48, s68
    buffer_load_dwordx4 v2, s[24:27], s48 offen lds
    s_addk_i32 m0, 4096
    s_add_u32 s48, s48, s68
    buffer_load_dwordx4 v2, s[24:27], s48 offen lds
    s_addk_i32 m0, 4096
    s_add_u32 s48, s48, s68
    buffer_load_dwordx4 v2, s[24:27], s48 offen lds
    s_add_u32 m0, s64, 52224
    s_add_u32 s48, s63, 9216
    buffer_load_dwordx4 v3, s[20:23], s48 offen lds
    s_addk_i32 m0, 1024
    s_add_u32 s48, s48, s69
    buffer_load_dwordx4 v3, s[20:23], s48 offen lds
    s_addk_i32 m0, 1024
    s_add_u32 s48, s48, s69
    buffer_load_dwordx4 v3, s[20:23], s48 offen lds
    s_addk_i32 m0, 1024
    s_add_u32 s48, s48, s69
    buffer_load_dwordx4 v3, s[20:23], s48 offen lds
    s_addk_i32 m0, 1024
    s_add_u32 s48, s48, s69
    s_mov_b64 exec, 0xffff
    buffer_load_dwordx4 v3, s[20:23], s48 offen lds
    s_mov_b64 exec, -1
    s_waitcnt vmcnt(18)
    s_barrier
    s_add_u32 m0, s62, 32768
    s_add_u32 s48, s61, 8421376
    buffer_load_dwordx4 v2, s[24:27], s48 offen lds
    s_addk_i32 m0, 4096
    s_add_u32 s48, s48, s68
    buffer_load_dwordx4 v2, s[24:27], s48 offen lds
    s_addk_i32 m0, 4096
    s_add_u32 s48, s48, s68
    buffer_load_dwordx4 v2, s[24:27], s48 offen lds
    s_addk_i32 m0, 4096
    s_add_u32 s48, s48, s68
    buffer_load_dwordx4 v2, s[24:27], s48 offen lds
    s_lshl3_add_u32 s46, s44, s43
    s_and_b32 s49, s47, 15
    s_lshl4_add_u32 s87, s40, s49
    s_mov_b64 s[28:29], s[18:19]
    s_mov_b32 s30, 268435456
    s_mov_b32 s31, 0x20000
    s_mov_b32 s60, 0x11111111
    s_lshl_b32 s60, s60, s58
    v_lshlrev_b32 v12, 4, v1
    v_mov_b32 v8, -1
    v_mov_b32 v9, -1
    v_mov_b32 v10, -1
    v_mov_b32 v11, -1
    s_lshl2_add_u32 s41, s46, s58
    s_lshl_b32 s41, s41, 17
    s_lshl2_add_u32 s48, s40, s42
    s_lshl_b32 s48, s48, 10
    s_add_u32 s41, s41, s48
    s_add_u32 s48, s41, 0
    buffer_store_dwordx4 v[8:11], v12, s[28:31], s48 offen sc1
    s_and_b32 exec_lo, s60, 0x0
    s_and_b32 exec_hi, s60, 0xffffffff
    buffer_load_dword v16, v7, s[24:27], s65 offen
    s_mov_b64 exec, -1
    s_waitcnt vmcnt(20)
    s_barrier
    s_add_u32 m0, s62, 49152
    s_add_u32 s48, s61, 12615680
    buffer_load_dwordx4 v2, s[24:27], s48 offen lds
    s_addk_i32 m0, 4096
    s_add_u32 s48, s48, s68
    buffer_load_dwordx4 v2, s[24:27], s48 offen lds
    s_addk_i32 m0, 4096
    s_add_u32 s48, s48, s68
    buffer_load_dwordx4 v2, s[24:27], s48 offen lds
    s_addk_i32 m0, 4096
    s_add_u32 s48, s48, s68
    buffer_load_dwordx4 v2, s[24:27], s48 offen lds
    s_add_u32 s48, s41, 2048
    buffer_store_dwordx4 v[8:11], v12, s[28:31], s48 offen sc1
    s_add_u32 s48, s41, 32768
    buffer_store_dwordx4 v[8:11], v12, s[28:31], s48 offen sc1
    s_waitcnt vmcnt(17)
    s_barrier
    s_add_u32 m0, s62, 65536
    s_add_u32 s48, s61, 524288
    buffer_load_dwordx4 v2, s[24:27], s48 offen lds
    s_addk_i32 m0, 4096
    s_add_u32 s48, s48, s68
    buffer_load_dwordx4 v2, s[24:27], s48 offen lds
    s_addk_i32 m0, 4096
    s_add_u32 s48, s48, s68
    buffer_load_dwordx4 v2, s[24:27], s48 offen lds
    s_addk_i32 m0, 4096
    s_add_u32 s48, s48, s68
    buffer_load_dwordx4 v2, s[24:27], s48 offen lds
    s_addk_i32 m0, 4096
    s_add_u32 s48, s48, s68
    buffer_load_dwordx4 v2, s[24:27], s48 offen lds
    s_addk_i32 m0, 4096
    s_add_u32 s48, s48, s68
    buffer_load_dwordx4 v2, s[24:27], s48 offen lds
    s_add_u32 s48, s41, 34816
    buffer_store_dwordx4 v[8:11], v12, s[28:31], s48 offen sc1
    s_waitcnt vmcnt(15)
    s_barrier
    s_mov_b32 m0, s62
    s_add_u32 s48, s61, 6815744
    buffer_load_dwordx4 v2, s[24:27], s48 offen lds
    s_addk_i32 m0, 4096
    s_add_u32 s48, s48, s68
    buffer_load_dwordx4 v2, s[24:27], s48 offen lds
    s_addk_i32 m0, 4096
    s_add_u32 s48, s48, s68
    buffer_load_dwordx4 v2, s[24:27], s48 offen lds
    s_addk_i32 m0, 4096
    s_add_u32 s48, s48, s68
    buffer_load_dwordx4 v2, s[24:27], s48 offen lds
    s_addk_i32 m0, 4096
    s_add_u32 s48, s48, s68
    buffer_load_dwordx4 v2, s[24:27], s48 offen lds
    s_addk_i32 m0, 4096
    s_add_u32 s48, s48, s68
    buffer_load_dwordx4 v2, s[24:27], s48 offen lds
    s_add_u32 s48, s41, 65536
    buffer_store_dwordx4 v[8:11], v12, s[28:31], s48 offen sc1
    s_waitcnt vmcnt(16)
    s_barrier
    s_add_u32 m0, s62, 24576
    s_add_u32 s48, s61, 13107200
    buffer_load_dwordx4 v2, s[24:27], s48 offen lds
    s_addk_i32 m0, 4096
    s_add_u32 s48, s48, s68
    buffer_load_dwordx4 v2, s[24:27], s48 offen lds
    s_addk_i32 m0, 4096
    s_add_u32 s48, s48, s68
    buffer_load_dwordx4 v2, s[24:27], s48 offen lds
    s_add_u32 m0, s62, 36864
    s_add_u32 s48, s61, 557056
    buffer_load_dwordx4 v2, s[24:27], s48 offen lds
    s_addk_i32 m0, 4096
    s_add_u32 s48, s48, s68
    buffer_load_dwordx4 v2, s[24:27], s48 offen lds
    s_addk_i32 m0, 4096
    s_add_u32 s48, s48, s68
    buffer_load_dwordx4 v2, s[24:27], s48 offen lds
    s_add_u32 s48, s41, 67584
    buffer_store_dwordx4 v[8:11], v12, s[28:31], s48 offen sc1
    s_waitcnt vmcnt(15)
    s_barrier
    s_add_u32 m0, s62, 49152
    s_add_u32 s48, s61, 3702784
    buffer_load_dwordx4 v2, s[24:27], s48 offen lds
    s_addk_i32 m0, 4096
    s_add_u32 s48, s48, s68
    buffer_load_dwordx4 v2, s[24:27], s48 offen lds
    s_addk_i32 m0, 4096
    s_add_u32 s48, s48, s68
    buffer_load_dwordx4 v2, s[24:27], s48 offen lds
    s_addk_i32 m0, 4096
    s_add_u32 s48, s48, s68
    buffer_load_dwordx4 v2, s[24:27], s48 offen lds
    s_add_u32 m0, s62, 90112
    s_add_u32 s48, s61, 7897088
    buffer_load_dwordx4 v2, s[24:27], s48 offen lds
    s_addk_i32 m0, 4096
    s_add_u32 s48, s48, s68
    buffer_load_dwordx4 v2, s[24:27], s48 offen lds
    s_add_u32 s48, s41, 98304
    buffer_store_dwordx4 v[8:11], v12, s[28:31], s48 offen sc1
    s_waitcnt vmcnt(15)
    s_barrier
    s_add_u32 m0, s62, 98304
    s_add_u32 s48, s61, 9994240
    buffer_load_dwordx4 v2, s[24:27], s48 offen lds
    s_addk_i32 m0, 4096
    s_add_u32 s48, s48, s68
    buffer_load_dwordx4 v2, s[24:27], s48 offen lds
    s_addk_i32 m0, 4096
    s_add_u32 s48, s48, s68
    buffer_load_dwordx4 v2, s[24:27], s48 offen lds
    s_addk_i32 m0, 4096
    s_add_u32 s48, s48, s68
    buffer_load_dwordx4 v2, s[24:27], s48 offen lds
    s_addk_i32 m0, 4096
    s_add_u32 s48, s48, s68
    buffer_load_dwordx4 v2, s[24:27], s48 offen lds
    s_addk_i32 m0, 4096
    s_add_u32 s48, s48, s68
    buffer_load_dwordx4 v2, s[24:27], s48 offen lds
    s_add_u32 s48, s41, 100352
    buffer_store_dwordx4 v[8:11], v12, s[28:31], s48 offen sc1
    s_waitcnt vmcnt(15)
    s_barrier
    s_waitcnt vmcnt(8)
    s_barrier
    s_waitcnt vmcnt(0)
    s_barrier
    v_and_b32 v4, 3, v1
    s_lshl_b32 s49, s87, 3
    v_lshl_add_u32 v4, v4, 1, s49
    global_load_ushort v208, v4, s[8:9]
    global_load_ushort v209, v4, s[10:11]
    global_load_ushort v210, v4, s[12:13]
    s_mov_b64 s[36:37], s[16:17]
    s_mov_b32 s38, 256
    s_mov_b32 s39, 0x20000
    s_waitcnt vmcnt(0) lgkmcnt(0)
    s_branch L_reduce
L_consumer:
    s_setprio 1
    s_getpc_b64 s[88:89]
L_pc:
    s_sub_u32 s88, s88, L_pc-standalone__self_sup_conv_stem_hubert__speech_kernel
    s_subb_u32 s89, s89, 0
    s_lshl2_add_u32 s48, s47, s45
    s_lshl_b32 s48, s48, 7
    v_lshlrev_b32 v4, 14, v1
    v_add_u32 v4, s48, v4
    v_cmp_gt_u32 vcc, L_end-standalone__self_sup_conv_stem_hubert__speech_kernel, v4
    s_and_saveexec_b64 s[66:67], vcc
    s_cbranch_execz L_nocode
    global_load_dword v215, v4, s[88:89]
L_nocode:
    s_mov_b64 exec, -1
    v_and_b32 v2, 15, v1
    v_lshrrev_b32 v3, 4, v1
    s_and_b32 s48, s45, 1
    s_lshl_b32 s48, s48, 11
    s_add_u32 s48, s48, 90112
    v_lshlrev_b32 v4, 4, v3
    v_add_u32 v5, 0, v2
    v_bfe_u32 v6, v5, 1, 2
    v_lshlrev_b32 v6, 5, v6
    v_xor_b32 v6, v6, v4
    v_lshl_add_u32 v6, v5, 7, v6
    v_add_u32 v196, s48, v6
    v_xor_b32 v197, 64, v196
    v_add_u32 v5, 1, v2
    v_bfe_u32 v6, v5, 1, 2
    v_lshlrev_b32 v6, 5, v6
    v_xor_b32 v6, v6, v4
    v_lshl_add_u32 v6, v5, 7, v6
    v_add_u32 v198, s48, v6
    v_xor_b32 v199, 64, v198
    v_add_u32 v5, 2, v2
    v_bfe_u32 v6, v5, 1, 2
    v_lshlrev_b32 v6, 5, v6
    v_xor_b32 v6, v6, v4
    v_lshl_add_u32 v6, v5, 7, v6
    v_add_u32 v200, s48, v6
    v_xor_b32 v201, 64, v200
    v_lshlrev_b32 v4, 10, v3
    v_lshrrev_b32 v5, 2, v2
    v_lshl_add_u32 v4, v5, 7, v4
    v_and_b32 v5, 3, v2
    v_lshl_add_u32 v4, v5, 3, v4
    v_lshrrev_b32 v5, 3, v2
    v_and_b32 v6, 1, v3
    v_lshl_or_b32 v5, v6, 1, v5
    s_and_b32 s48, s45, 2
    v_xor_b32 v5, s48, v5
    v_lshl_add_u32 v202, v5, 5, v4
    v_xor_b32 v203, 32, v202
    v_add_u32 v204, 0x10000, v202
    v_add_u32 v205, 0x10000, v203
    s_waitcnt lgkmcnt(0)
    s_lshl3_add_u32 s46, s44, s43
    s_and_b32 s49, s47, 15
    s_lshl4_add_u32 s87, s40, s49
    s_mov_b64 s[28:29], s[18:19]
    s_mov_b32 s30, 268435456
    s_mov_b32 s31, 0x20000
    s_mov_b64 s[36:37], s[16:17]
    s_mov_b32 s38, 256
    s_mov_b32 s39, 0x20000
    v_lshlrev_b32 v4, 15, v3
    v_lshl_add_u32 v206, v2, 4, v4
    s_lshr_b32 s49, s45, 1
    s_lshl1_add_u32 s63, s46, s49
    s_lshl_b32 s63, s63, 18
    s_lshl2_add_u32 s49, s40, s42
    s_and_b32 s50, s45, 1
    s_lshl1_add_u32 s49, s49, s50
    s_lshl_b32 s49, s49, 9
    s_add_u32 s63, s63, s49
    s_add_u32 s64, s63, 131072
    s_lshl_b32 s49, s46, 4
    v_lshl_add_u32 v212, v0, 12, s49
    v_mov_b32 v213, 1
    s_barrier
    ds_read_b64_tr_b16 v[164:165], v202 offset:0
    ds_read_b64_tr_b16 v[166:167], v202 offset:512
    ds_read_b64_tr_b16 v[172:173], v202 offset:4096
    ds_read_b64_tr_b16 v[174:175], v202 offset:4608
    ds_read_b128 v[72:75], v196 offset:0
    ds_read_b128 v[76:79], v196 offset:4352
    ds_read_b64_tr_b16 v[168:169], v203 offset:0
    ds_read_b64_tr_b16 v[170:171], v203 offset:512
    ds_read_b64_tr_b16 v[176:177], v203 offset:4096
    ds_read_b64_tr_b16 v[178:179], v203 offset:4608
    ds_read_b128 v[80:83], v196 offset:8704
    ds_read_b128 v[84:87], v196 offset:13056
    s_waitcnt lgkmcnt(7)
    v_mfma_f32_16x16x32_bf16 v[8:11], v[164:167], v[72:75], 0
    s_waitcnt lgkmcnt(6)
    v_mfma_f32_16x16x32_bf16 v[8:11], v[172:175], v[76:79], v[8:11]
    s_waitcnt lgkmcnt(4)
    v_mfma_f32_16x16x32_bf16 v[12:15], v[168:171], v[72:75], 0
    s_waitcnt lgkmcnt(2)
    v_mfma_f32_16x16x32_bf16 v[12:15], v[176:179], v[76:79], v[12:15]
    v_mfma_f32_16x16x32_bf16 v[16:19], v[164:167], v[76:79], 0
    s_waitcnt lgkmcnt(1)
    v_mfma_f32_16x16x32_bf16 v[16:19], v[172:175], v[80:83], v[16:19]
    v_mfma_f32_16x16x32_bf16 v[20:23], v[168:171], v[76:79], 0
    v_mfma_f32_16x16x32_bf16 v[20:23], v[176:179], v[80:83], v[20:23]
    v_mfma_f32_16x16x32_bf16 v[24:27], v[164:167], v[80:83], 0
    s_waitcnt lgkmcnt(0)
    v_mfma_f32_16x16x32_bf16 v[24:27], v[172:175], v[84:87], v[24:27]
    s_barrier
    ds_read_b128 v[88:91], v196 offset:17408
    v_mfma_f32_16x16x32_bf16 v[28:31], v[168:171], v[80:83], 0
    ds_read_b128 v[92:95], v196 offset:21760
    v_mfma_f32_16x16x32_bf16 v[28:31], v[176:179], v[84:87], v[28:31]
    ds_read_b128 v[96:99], v196 offset:26112
    v_mfma_f32_16x16x32_bf16 v[32:35], v[164:167], v[84:87], 0
    ds_read_b128 v[100:103], v196 offset:30464
    s_waitcnt lgkmcnt(3)
    v_mfma_f32_16x16x32_bf16 v[32:35], v[172:175], v[88:91], v[32:35]
    ds_read_b128 v[104:107], v198 offset:0
    v_mfma_f32_16x16x32_bf16 v[36:39], v[168:171], v[84:87], 0
    ds_read_b64_tr_b16 v[180:181], v202 offset:8192
    v_mfma_f32_16x16x32_bf16 v[36:39], v[176:179], v[88:91], v[36:39]
    ds_read_b64_tr_b16 v[182:183], v202 offset:8704
    v_mfma_f32_16x16x32_bf16 v[40:43], v[164:167], v[88:91], 0
    ds_read_b64_tr_b16 v[188:189], v202 offset:12288
    s_waitcnt lgkmcnt(6)
    v_mfma_f32_16x16x32_bf16 v[40:43], v[172:175], v[92:95], v[40:43]
    ds_read_b64_tr_b16 v[190:191], v202 offset:12800
    v_mfma_f32_16x16x32_bf16 v[44:47], v[168:171], v[88:91], 0
    ds_read_b64_tr_b16 v[184:185], v203 offset:8192
    v_mfma_f32_16x16x32_bf16 v[44:47], v[176:179], v[92:95], v[44:47]
    ds_read_b64_tr_b16 v[186:187], v203 offset:8704
    v_mfma_f32_16x16x32_bf16 v[48:51], v[164:167], v[92:95], 0
    ds_read_b64_tr_b16 v[192:193], v203 offset:12288
    s_waitcnt lgkmcnt(9)
    v_mfma_f32_16x16x32_bf16 v[48:51], v[172:175], v[96:99], v[48:51]
    ds_read_b64_tr_b16 v[194:195], v203 offset:12800
    v_mfma_f32_16x16x32_bf16 v[52:55], v[168:171], v[92:95], 0
    ds_read_b128 v[108:111], v198 offset:4352
    v_mfma_f32_16x16x32_bf16 v[52:55], v[176:179], v[96:99], v[52:55]
    ds_read_b128 v[112:115], v198 offset:8704
    v_mfma_f32_16x16x32_bf16 v[56:59], v[164:167], v[96:99], 0
    ds_read_b128 v[116:119], v198 offset:13056
    s_waitcnt lgkmcnt(12)
    v_mfma_f32_16x16x32_bf16 v[56:59], v[172:175], v[100:103], v[56:59]
    ds_read_b128 v[120:123], v198 offset:17408
    v_mfma_f32_16x16x32_bf16 v[60:63], v[168:171], v[96:99], 0
    v_mfma_f32_16x16x32_bf16 v[60:63], v[176:179], v[100:103], v[60:63]
    v_mfma_f32_16x16x32_bf16 v[64:67], v[164:167], v[100:103], 0
    s_waitcnt lgkmcnt(12)
    v_mfma_f32_16x16x32_bf16 v[64:67], v[172:175], v[104:107], v[64:67]
    v_mfma_f32_16x16x32_bf16 v[68:71], v[168:171], v[100:103], 0
    v_mfma_f32_16x16x32_bf16 v[68:71], v[176:179], v[104:107], v[68:71]
    s_waitcnt lgkmcnt(4)
    v_mfma_f32_16x16x32_bf16 v[12:15], v[184:187], v[80:83], v[12:15]
    s_barrier
    ds_read_b64_tr_b16 v[164:165], v202 offset:16384
    v_mfma_f32_16x16x32_bf16 v[12:15], v[192:195], v[84:87], v[12:15]
    ds_read_b64_tr_b16 v[166:167], v202 offset:16896
    v_mfma_f32_16x16x32_bf16 v[20:23], v[184:187], v[84:87], v[20:23]
    ds_read_b64_tr_b16 v[172:173], v202 offset:20480
    v_mfma_f32_16x16x32_bf16 v[20:23], v[192:195], v[88:91], v[20:23]
    ds_read_b64_tr_b16 v[174:175], v202 offset:20992
    v_mfma_f32_16x16x32_bf16 v[28:31], v[184:187], v[88:91], v[28:31]
    ds_read_b64_tr_b16 v[168:169], v203 offset:16384
    v_mfma_f32_16x16x32_bf16 v[28:31], v[192:195], v[92:95], v[28:31]
    ds_read_b64_tr_b16 v[170:171], v203 offset:16896
    v_mfma_f32_16x16x32_bf16 v[36:39], v[184:187], v[92:95], v[36:39]
    ds_read_b64_tr_b16 v[176:177], v203 offset:20480
    v_mfma_f32_16x16x32_bf16 v[36:39], v[192:195], v[96:99], v[36:39]
    ds_read_b64_tr_b16 v[178:179], v203 offset:20992
    v_mfma_f32_16x16x32_bf16 v[44:47], v[184:187], v[96:99], v[44:47]
    ds_read_b128 v[124:127], v198 offset:21760
    v_mfma_f32_16x16x32_bf16 v[44:47], v[192:195], v[100:103], v[44:47]
    ds_read_b128 v[128:131], v198 offset:26112
    v_mfma_f32_16x16x32_bf16 v[52:55], v[184:187], v[100:103], v[52:55]
    ds_read_b128 v[132:135], v198 offset:30464
    v_mfma_f32_16x16x32_bf16 v[52:55], v[192:195], v[104:107], v[52:55]
    ds_read_b128 v[136:139], v200 offset:0
    v_mfma_f32_16x16x32_bf16 v[60:63], v[184:187], v[104:107], v[60:63]
    s_waitcnt lgkmcnt(15)
    v_mfma_f32_16x16x32_bf16 v[60:63], v[192:195], v[108:111], v[60:63]
    v_mfma_f32_16x16x32_bf16 v[68:71], v[184:187], v[108:111], v[68:71]
    s_waitcnt lgkmcnt(14)
    v_mfma_f32_16x16x32_bf16 v[68:71], v[192:195], v[112:115], v[68:71]
    v_mfma_f32_16x16x32_bf16 v[64:67], v[188:191], v[112:115], v[64:67]
    v_mfma_f32_16x16x32_bf16 v[64:67], v[180:183], v[108:111], v[64:67]
    v_mfma_f32_16x16x32_bf16 v[56:59], v[188:191], v[108:111], v[56:59]
    v_mfma_f32_16x16x32_bf16 v[56:59], v[180:183], v[104:107], v[56:59]
    v_mfma_f32_16x16x32_bf16 v[48:51], v[188:191], v[104:107], v[48:51]
    v_mfma_f32_16x16x32_bf16 v[48:51], v[180:183], v[100:103], v[48:51]
    v_mfma_f32_16x16x32_bf16 v[40:43], v[188:191], v[100:103], v[40:43]
    v_mfma_f32_16x16x32_bf16 v[40:43], v[180:183], v[96:99], v[40:43]
    v_mfma_f32_16x16x32_bf16 v[32:35], v[188:191], v[96:99], v[32:35]
    v_mfma_f32_16x16x32_bf16 v[32:35], v[180:183], v[92:95], v[32:35]
    v_mfma_f32_16x16x32_bf16 v[24:27], v[188:191], v[92:95], v[24:27]
    v_mfma_f32_16x16x32_bf16 v[24:27], v[180:183], v[88:91], v[24:27]
    v_mfma_f32_16x16x32_bf16 v[16:19], v[188:191], v[88:91], v[16:19]
    v_mfma_f32_16x16x32_bf16 v[16:19], v[180:183], v[84:87], v[16:19]
    v_mfma_f32_16x16x32_bf16 v[8:11], v[188:191], v[84:87], v[8:11]
    v_mfma_f32_16x16x32_bf16 v[8:11], v[180:183], v[80:83], v[8:11]
    s_waitcnt lgkmcnt(4)
    v_mfma_f32_16x16x32_bf16 v[8:11], v[164:167], v[88:91], v[8:11]
    ds_read_b64_tr_b16 v[180:181], v202 offset:24576
    v_mfma_f32_16x16x32_bf16 v[8:11], v[172:175], v[92:95], v[8:11]
    ds_read_b64_tr_b16 v[182:183], v202 offset:25088
    v_mfma_f32_16x16x32_bf16 v[16:19], v[164:167], v[92:95], v[16:19]
    ds_read_b64_tr_b16 v[188:189], v202 offset:28672
    v_mfma_f32_16x16x32_bf16 v[16:19], v[172:175], v[96:99], v[16:19]
    ds_read_b64_tr_b16 v[190:191], v202 offset:29184
    v_mfma_f32_16x16x32_bf16 v[24:27], v[164:167], v[96:99], v[24:27]
    ds_read_b64_tr_b16 v[184:185], v203 offset:24576
    v_mfma_f32_16x16x32_bf16 v[24:27], v[172:175], v[100:103], v[24:27]
    ds_read_b64_tr_b16 v[186:187], v203 offset:25088
    v_mfma_f32_16x16x32_bf16 v[32:35], v[164:167], v[100:103], v[32:35]
    ds_read_b64_tr_b16 v[192:193], v203 offset:28672
    v_mfma_f32_16x16x32_bf16 v[32:35], v[172:175], v[104:107], v[32:35]
    ds_read_b64_tr_b16 v[194:195], v203 offset:29184
    v_mfma_f32_16x16x32_bf16 v[40:43], v[164:167], v[104:107], v[40:43]
    ds_read_b128 v[140:143], v200 offset:4352
    v_mfma_f32_16x16x32_bf16 v[40:43], v[172:175], v[108:111], v[40:43]
    ds_read_b128 v[144:147], v200 offset:8704
    v_mfma_f32_16x16x32_bf16 v[48:51], v[164:167], v[108:111], v[48:51]
    ds_read_b128 v[148:151], v200 offset:13056
    v_mfma_f32_16x16x32_bf16 v[48:51], v[172:175], v[112:115], v[48:51]
    ds_read_b128 v[152:155], v200 offset:17408
    v_mfma_f32_16x16x32_bf16 v[56:59], v[164:167], v[112:115], v[56:59]
    v_mfma_f32_16x16x32_bf16 v[56:59], v[172:175], v[116:119], v[56:59]
    v_mfma_f32_16x16x32_bf16 v[64:67], v[164:167], v[116:119], v[64:67]
    v_mfma_f32_16x16x32_bf16 v[64:67], v[172:175], v[120:123], v[64:67]
    v_mfma_f32_16x16x32_bf16 v[68:71], v[176:179], v[120:123], v[68:71]
    v_mfma_f32_16x16x32_bf16 v[68:71], v[168:171], v[116:119], v[68:71]
    v_mfma_f32_16x16x32_bf16 v[60:63], v[176:179], v[116:119], v[60:63]
    v_mfma_f32_16x16x32_bf16 v[60:63], v[168:171], v[112:115], v[60:63]
    v_mfma_f32_16x16x32_bf16 v[52:55], v[176:179], v[112:115], v[52:55]
    v_mfma_f32_16x16x32_bf16 v[52:55], v[168:171], v[108:111], v[52:55]
    v_mfma_f32_16x16x32_bf16 v[44:47], v[176:179], v[108:111], v[44:47]
    v_mfma_f32_16x16x32_bf16 v[44:47], v[168:171], v[104:107], v[44:47]
    v_mfma_f32_16x16x32_bf16 v[36:39], v[176:179], v[104:107], v[36:39]
    v_mfma_f32_16x16x32_bf16 v[36:39], v[168:171], v[100:103], v[36:39]
    v_mfma_f32_16x16x32_bf16 v[28:31], v[176:179], v[100:103], v[28:31]
    v_mfma_f32_16x16x32_bf16 v[28:31], v[168:171], v[96:99], v[28:31]
    v_mfma_f32_16x16x32_bf16 v[20:23], v[176:179], v[96:99], v[20:23]
    v_mfma_f32_16x16x32_bf16 v[20:23], v[168:171], v[92:95], v[20:23]
    v_mfma_f32_16x16x32_bf16 v[12:15], v[176:179], v[92:95], v[12:15]
    v_mfma_f32_16x16x32_bf16 v[12:15], v[168:171], v[88:91], v[12:15]
    s_waitcnt lgkmcnt(4)
    v_mfma_f32_16x16x32_bf16 v[12:15], v[184:187], v[96:99], v[12:15]
    s_barrier
    ds_read_b64_tr_b16 v[164:165], v202 offset:32768
    v_mfma_f32_16x16x32_bf16 v[12:15], v[192:195], v[100:103], v[12:15]
    ds_read_b64_tr_b16 v[166:167], v202 offset:33280
    v_mfma_f32_16x16x32_bf16 v[20:23], v[184:187], v[100:103], v[20:23]
    s_branch L_over0
L_pad0:
    s_branch L_hopped
L_over0:
    ds_read_b64_tr_b16 v[172:173], v202 offset:36864
    v_mfma_f32_16x16x32_bf16 v[20:23], v[192:195], v[104:107], v[20:23]
    ds_read_b64_tr_b16 v[174:175], v202 offset:37376
    v_mfma_f32_16x16x32_bf16 v[28:31], v[184:187], v[104:107], v[28:31]
    ds_read_b64_tr_b16 v[168:169], v203 offset:32768
    v_mfma_f32_16x16x32_bf16 v[28:31], v[192:195], v[108:111], v[28:31]
    ds_read_b64_tr_b16 v[170:171], v203 offset:33280
    v_mfma_f32_16x16x32_bf16 v[36:39], v[184:187], v[108:111], v[36:39]
    ds_read_b64_tr_b16 v[176:177], v203 offset:36864
    v_mfma_f32_16x16x32_bf16 v[36:39], v[192:195], v[112:115], v[36:39]
    ds_read_b64_tr_b16 v[178:179], v203 offset:37376
    v_mfma_f32_16x16x32_bf16 v[44:47], v[184:187], v[112:115], v[44:47]
    ds_read_b128 v[156:159], v200 offset:21760
    v_mfma_f32_16x16x32_bf16 v[44:47], v[192:195], v[116:119], v[44:47]
    ds_read_b128 v[160:163], v200 offset:26112
    v_mfma_f32_16x16x32_bf16 v[52:55], v[184:187], v[116:119], v[52:55]
    ds_read_b128 v[72:75], v197 offset:0
    v_mfma_f32_16x16x32_bf16 v[52:55], v[192:195], v[120:123], v[52:55]
    ds_read_b128 v[76:79], v197 offset:4352
    v_mfma_f32_16x16x32_bf16 v[60:63], v[184:187], v[120:123], v[60:63]
    v_mfma_f32_16x16x32_bf16 v[60:63], v[192:195], v[124:127], v[60:63]
    v_mfma_f32_16x16x32_bf16 v[68:71], v[184:187], v[124:127], v[68:71]
    v_mfma_f32_16x16x32_bf16 v[68:71], v[192:195], v[128:131], v[68:71]
    v_mfma_f32_16x16x32_bf16 v[64:67], v[188:191], v[128:131], v[64:67]
    v_mfma_f32_16x16x32_bf16 v[64:67], v[180:183], v[124:127], v[64:67]
    v_mfma_f32_16x16x32_bf16 v[56:59], v[188:191], v[124:127], v[56:59]
    v_mfma_f32_16x16x32_bf16 v[56:59], v[180:183], v[120:123], v[56:59]
    v_mfma_f32_16x16x32_bf16 v[48:51], v[188:191], v[120:123], v[48:51]
    v_mfma_f32_16x16x32_bf16 v[48:51], v[180:183], v[116:119], v[48:51]
    v_mfma_f32_16x16x32_bf16 v[40:43], v[188:191], v[116:119], v[40:43]
    v_mfma_f32_16x16x32_bf16 v[40:43], v[180:183], v[112:115], v[40:43]
    v_mfma_f32_16x16x32_bf16 v[32:35], v[188:191], v[112:115], v[32:35]
    v_mfma_f32_16x16x32_bf16 v[32:35], v[180:183], v[108:111], v[32:35]
    v_mfma_f32_16x16x32_bf16 v[24:27], v[188:191], v[108:111], v[24:27]
    v_mfma_f32_16x16x32_bf16 v[24:27], v[180:183], v[104:107], v[24:27]
    v_mfma_f32_16x16x32_bf16 v[16:19], v[188:191], v[104:107], v[16:19]
    v_mfma_f32_16x16x32_bf16 v[16:19], v[180:183], v[100:103], v[16:19]
    v_mfma_f32_16x16x32_bf16 v[8:11], v[188:191], v[100:103], v[8:11]
    v_mfma_f32_16x16x32_bf16 v[8:11], v[180:183], v[96:99], v[8:11]
    s_waitcnt lgkmcnt(4)
    v_mfma_f32_16x16x32_bf16 v[8:11], v[164:167], v[104:107], v[8:11]
    ds_read_b64_tr_b16 v[180:181], v202 offset:40960
    v_mfma_f32_16x16x32_bf16 v[8:11], v[172:175], v[108:111], v[8:11]
    ds_read_b64_tr_b16 v[182:183], v202 offset:41472
    v_mfma_f32_16x16x32_bf16 v[16:19], v[164:167], v[108:111], v[16:19]
    ds_read_b64_tr_b16 v[188:189], v202 offset:45056
    v_mfma_f32_16x16x32_bf16 v[16:19], v[172:175], v[112:115], v[16:19]
    ds_read_b64_tr_b16 v[190:191], v202 offset:45568
    v_mfma_f32_16x16x32_bf16 v[24:27], v[164:167], v[112:115], v[24:27]
    ds_read_b64_tr_b16 v[184:185], v203 offset:40960
    v_mfma_f32_16x16x32_bf16 v[24:27], v[172:175], v[116:119], v[24:27]
    ds_read_b64_tr_b16 v[186:187], v203 offset:41472
    v_mfma_f32_16x16x32_bf16 v[32:35], v[164:167], v[116:119], v[32:35]
    ds_read_b64_tr_b16 v[192:193], v203 offset:45056
    v_mfma_f32_16x16x32_bf16 v[32:35], v[172:175], v[120:123], v[32:35]
    ds_read_b64_tr_b16 v[194:195], v203 offset:45568
    v_mfma_f32_16x16x32_bf16 v[40:43], v[164:167], v[120:123], v[40:43]
    ds_read_b128 v[80:83], v197 offset:8704
    v_mfma_f32_16x16x32_bf16 v[40:43], v[172:175], v[124:127], v[40:43]
    ds_read_b128 v[84:87], v197 offset:13056
    v_mfma_f32_16x16x32_bf16 v[48:51], v[164:167], v[124:127], v[48:51]
    ds_read_b128 v[88:91], v197 offset:17408
    v_mfma_f32_16x16x32_bf16 v[48:51], v[172:175], v[128:131], v[48:51]
    ds_read_b128 v[92:95], v197 offset:21760
    v_mfma_f32_16x16x32_bf16 v[56:59], v[164:167], v[128:131], v[56:59]
    v_mfma_f32_16x16x32_bf16 v[56:59], v[172:175], v[132:135], v[56:59]
    v_mfma_f32_16x16x32_bf16 v[64:67], v[164:167], v[132:135], v[64:67]
    v_mfma_f32_16x16x32_bf16 v[64:67], v[172:175], v[136:139], v[64:67]
    v_mfma_f32_16x16x32_bf16 v[68:71], v[176:179], v[136:139], v[68:71]
    v_mfma_f32_16x16x32_bf16 v[68:71], v[168:171], v[132:135], v[68:71]
    v_mfma_f32_16x16x32_bf16 v[60:63], v[176:179], v[132:135], v[60:63]
    v_mfma_f32_16x16x32_bf16 v[60:63], v[168:171], v[128:131], v[60:63]
    v_mfma_f32_16x16x32_bf16 v[52:55], v[176:179], v[128:131], v[52:55]
    v_mfma_f32_16x16x32_bf16 v[52:55], v[168:171], v[124:127], v[52:55]
    v_mfma_f32_16x16x32_bf16 v[44:47], v[176:179], v[124:127], v[44:47]
    v_mfma_f32_16x16x32_bf16 v[44:47], v[168:171], v[120:123], v[44:47]
    v_mfma_f32_16x16x32_bf16 v[36:39], v[176:179], v[120:123], v[36:39]
    v_mfma_f32_16x16x32_bf16 v[36:39], v[168:171], v[116:119], v[36:39]
    v_mfma_f32_16x16x32_bf16 v[28:31], v[176:179], v[116:119], v[28:31]
    v_mfma_f32_16x16x32_bf16 v[28:31], v[168:171], v[112:115], v[28:31]
    v_mfma_f32_16x16x32_bf16 v[20:23], v[176:179], v[112:115], v[20:23]
    v_mfma_f32_16x16x32_bf16 v[20:23], v[168:171], v[108:111], v[20:23]
    v_mfma_f32_16x16x32_bf16 v[12:15], v[176:179], v[108:111], v[12:15]
    v_mfma_f32_16x16x32_bf16 v[12:15], v[168:171], v[104:107], v[12:15]
    s_waitcnt lgkmcnt(4)
    v_mfma_f32_16x16x32_bf16 v[12:15], v[184:187], v[112:115], v[12:15]
    s_barrier
    ds_read_b64_tr_b16 v[164:165], v202 offset:49152
    v_mfma_f32_16x16x32_bf16 v[12:15], v[192:195], v[116:119], v[12:15]
    ds_read_b64_tr_b16 v[166:167], v202 offset:49664
    v_mfma_f32_16x16x32_bf16 v[20:23], v[184:187], v[116:119], v[20:23]
    ds_read_b64_tr_b16 v[172:173], v202 offset:53248
    v_mfma_f32_16x16x32_bf16 v[20:23], v[192:195], v[120:123], v[20:23]
    ds_read_b64_tr_b16 v[174:175], v202 offset:53760
    v_mfma_f32_16x16x32_bf16 v[28:31], v[184:187], v[120:123], v[28:31]
    ds_read_b64_tr_b16 v[168:169], v203 offset:49152
    v_mfma_f32_16x16x32_bf16 v[28:31], v[192:195], v[124:127], v[28:31]
    ds_read_b64_tr_b16 v[170:171], v203 offset:49664
    v_mfma_f32_16x16x32_bf16 v[36:39], v[184:187], v[124:127], v[36:39]
    ds_read_b64_tr_b16 v[176:177], v203 offset:53248
    v_mfma_f32_16x16x32_bf16 v[36:39], v[192:195], v[128:131], v[36:39]
    ds_read_b64_tr_b16 v[178:179], v203 offset:53760
    v_mfma_f32_16x16x32_bf16 v[44:47], v[184:187], v[128:131], v[44:47]
    ds_read_b128 v[96:99], v197 offset:26112
    v_mfma_f32_16x16x32_bf16 v[44:47], v[192:195], v[132:135], v[44:47]
    ds_read_b128 v[100:103], v197 offset:30464
    v_mfma_f32_16x16x32_bf16 v[52:55], v[184:187], v[132:135], v[52:55]
    ds_read_b128 v[104:107], v199 offset:0
    v_mfma_f32_16x16x32_bf16 v[52:55], v[192:195], v[136:139], v[52:55]
    ds_read_b128 v[108:111], v199 offset:4352
    v_mfma_f32_16x16x32_bf16 v[60:63], v[184:187], v[136:139], v[60:63]
    v_mfma_f32_16x16x32_bf16 v[60:63], v[192:195], v[140:143], v[60:63]
    v_mfma_f32_16x16x32_bf16 v[68:71], v[184:187], v[140:143], v[68:71]
    v_mfma_f32_16x16x32_bf16 v[68:71], v[192:195], v[144:147], v[68:71]
    v_mfma_f32_16x16x32_bf16 v[64:67], v[188:191], v[144:147], v[64:67]
    v_mfma_f32_16x16x32_bf16 v[64:67], v[180:183], v[140:143], v[64:67]
    v_mfma_f32_16x16x32_bf16 v[56:59], v[188:191], v[140:143], v[56:59]
    v_mfma_f32_16x16x32_bf16 v[56:59], v[180:183], v[136:139], v[56:59]
    v_mfma_f32_16x16x32_bf16 v[48:51], v[188:191], v[136:139], v[48:51]
    v_mfma_f32_16x16x32_bf16 v[48:51], v[180:183], v[132:135], v[48:51]
    v_mfma_f32_16x16x32_bf16 v[40:43], v[188:191], v[132:135], v[40:43]
    v_mfma_f32_16x16x32_bf16 v[40:43], v[180:183], v[128:131], v[40:43]
    v_mfma_f32_16x16x32_bf16 v[32:35], v[188:191], v[128:131], v[32:35]
    v_mfma_f32_16x16x32_bf16 v[32:35], v[180:183], v[124:127], v[32:35]
    v_mfma_f32_16x16x32_bf16 v[24:27], v[188:191], v[124:127], v[24:27]
    v_mfma_f32_16x16x32_bf16 v[24:27], v[180:183], v[120:123], v[24:27]
    v_mfma_f32_16x16x32_bf16 v[16:19], v[188:191], v[120:123], v[16:19]
    v_mfma_f32_16x16x32_bf16 v[16:19], v[180:183], v[116:119], v[16:19]
    v_mfma_f32_16x16x32_bf16 v[8:11], v[188:191], v[116:119], v[8:11]
    v_mfma_f32_16x16x32_bf16 v[8:11], v[180:183], v[112:115], v[8:11]
    s_waitcnt lgkmcnt(4)
    v_mfma_f32_16x16x32_bf16 v[8:11], v[164:167], v[120:123], v[8:11]
    ds_read_b64_tr_b16 v[180:181], v202 offset:57344
    v_mfma_f32_16x16x32_bf16 v[8:11], v[172:175], v[124:127], v[8:11]
    ds_read_b64_tr_b16 v[182:183], v202 offset:57856
    v_mfma_f32_16x16x32_bf16 v[16:19], v[164:167], v[124:127], v[16:19]
    ds_read_b64_tr_b16 v[188:189], v202 offset:61440
    v_mfma_f32_16x16x32_bf16 v[16:19], v[172:175], v[128:131], v[16:19]
    ds_read_b64_tr_b16 v[190:191], v202 offset:61952
    v_mfma_f32_16x16x32_bf16 v[24:27], v[164:167], v[128:131], v[24:27]
    ds_read_b64_tr_b16 v[184:185], v203 offset:57344
    v_mfma_f32_16x16x32_bf16 v[24:27], v[172:175], v[132:135], v[24:27]
    ds_read_b64_tr_b16 v[186:187], v203 offset:57856
    v_mfma_f32_16x16x32_bf16 v[32:35], v[164:167], v[132:135], v[32:35]
    ds_read_b64_tr_b16 v[192:193], v203 offset:61440
    v_mfma_f32_16x16x32_bf16 v[32:35], v[172:175], v[136:139], v[32:35]
    ds_read_b64_tr_b16 v[194:195], v203 offset:61952
    v_mfma_f32_16x16x32_bf16 v[40:43], v[164:167], v[136:139], v[40:43]
    ds_read_b128 v[112:115], v199 offset:8704
    v_mfma_f32_16x16x32_bf16 v[40:43], v[172:175], v[140:143], v[40:43]
    ds_read_b128 v[116:119], v199 offset:13056
    v_mfma_f32_16x16x32_bf16 v[48:51], v[164:167], v[140:143], v[48:51]
    v_mfma_f32_16x16x32_bf16 v[48:51], v[172:175], v[144:147], v[48:51]
    v_mfma_f32_16x16x32_bf16 v[56:59], v[164:167], v[144:147], v[56:59]
    v_mfma_f32_16x16x32_bf16 v[56:59], v[172:175], v[148:151], v[56:59]
    v_mfma_f32_16x16x32_bf16 v[64:67], v[164:167], v[148:151], v[64:67]
    v_mfma_f32_16x16x32_bf16 v[64:67], v[172:175], v[152:155], v[64:67]
    v_mfma_f32_16x16x32_bf16 v[68:71], v[176:179], v[152:155], v[68:71]
    v_mfma_f32_16x16x32_bf16 v[68:71], v[168:171], v[148:151], v[68:71]
    v_mfma_f32_16x16x32_bf16 v[60:63], v[176:179], v[148:151], v[60:63]
    v_mfma_f32_16x16x32_bf16 v[60:63], v[168:171], v[144:147], v[60:63]
    v_mfma_f32_16x16x32_bf16 v[52:55], v[176:179], v[144:147], v[52:55]
    v_mfma_f32_16x16x32_bf16 v[52:55], v[168:171], v[140:143], v[52:55]
    v_mfma_f32_16x16x32_bf16 v[44:47], v[176:179], v[140:143], v[44:47]
    v_mfma_f32_16x16x32_bf16 v[44:47], v[168:171], v[136:139], v[44:47]
    v_mfma_f32_16x16x32_bf16 v[36:39], v[176:179], v[136:139], v[36:39]
    v_mfma_f32_16x16x32_bf16 v[36:39], v[168:171], v[132:135], v[36:39]
    v_mfma_f32_16x16x32_bf16 v[28:31], v[176:179], v[132:135], v[28:31]
    v_mfma_f32_16x16x32_bf16 v[28:31], v[168:171], v[128:131], v[28:31]
    v_mfma_f32_16x16x32_bf16 v[20:23], v[176:179], v[128:131], v[20:23]
    v_mfma_f32_16x16x32_bf16 v[20:23], v[168:171], v[124:127], v[20:23]
    v_mfma_f32_16x16x32_bf16 v[12:15], v[176:179], v[124:127], v[12:15]
    v_mfma_f32_16x16x32_bf16 v[12:15], v[168:171], v[120:123], v[12:15]
    s_waitcnt lgkmcnt(2)
    v_mfma_f32_16x16x32_bf16 v[12:15], v[184:187], v[128:131], v[12:15]
    s_barrier
    ds_read_b64_tr_b16 v[164:165], v202 offset:0
    v_mfma_f32_16x16x32_bf16 v[12:15], v[192:195], v[132:135], v[12:15]
    ds_read_b64_tr_b16 v[166:167], v202 offset:512
    v_mfma_f32_16x16x32_bf16 v[20:23], v[184:187], v[132:135], v[20:23]
    ds_read_b64_tr_b16 v[172:173], v202 offset:4096
    v_mfma_f32_16x16x32_bf16 v[20:23], v[192:195], v[136:139], v[20:23]
    ds_read_b64_tr_b16 v[174:175], v202 offset:4608
    v_mfma_f32_16x16x32_bf16 v[28:31], v[184:187], v[136:139], v[28:31]
    ds_read_b64_tr_b16 v[168:169], v203 offset:0
    v_mfma_f32_16x16x32_bf16 v[28:31], v[192:195], v[140:143], v[28:31]
    ds_read_b64_tr_b16 v[170:171], v203 offset:512
    v_mfma_f32_16x16x32_bf16 v[36:39], v[184:187], v[140:143], v[36:39]
    ds_read_b64_tr_b16 v[176:177], v203 offset:4096
    v_mfma_f32_16x16x32_bf16 v[36:39], v[192:195], v[144:147], v[36:39]
    ds_read_b64_tr_b16 v[178:179], v203 offset:4608
    v_mfma_f32_16x16x32_bf16 v[44:47], v[184:187], v[144:147], v[44:47]
    ds_read_b128 v[120:123], v199 offset:17408
    v_mfma_f32_16x16x32_bf16 v[44:47], v[192:195], v[148:151], v[44:47]
    ds_read_b128 v[124:127], v199 offset:21760
    v_mfma_f32_16x16x32_bf16 v[52:55], v[184:187], v[148:151], v[52:55]
    v_mfma_f32_16x16x32_bf16 v[52:55], v[192:195], v[152:155], v[52:55]
    v_mfma_f32_16x16x32_bf16 v[60:63], v[184:187], v[152:155], v[60:63]
    v_mfma_f32_16x16x32_bf16 v[60:63], v[192:195], v[156:159], v[60:63]
    v_mfma_f32_16x16x32_bf16 v[68:71], v[184:187], v[156:159], v[68:71]
    v_mfma_f32_16x16x32_bf16 v[68:71], v[192:195], v[160:163], v[68:71]
    v_mfma_f32_16x16x32_bf16 v[64:67], v[188:191], v[160:163], v[64:67]
    v_mfma_f32_16x16x32_bf16 v[64:67], v[180:183], v[156:159], v[64:67]
    v_mfma_f32_16x16x32_bf16 v[56:59], v[188:191], v[156:159], v[56:59]
    v_mfma_f32_16x16x32_bf16 v[56:59], v[180:183], v[152:155], v[56:59]
    v_mfma_f32_16x16x32_bf16 v[48:51], v[188:191], v[152:155], v[48:51]
    v_mfma_f32_16x16x32_bf16 v[48:51], v[180:183], v[148:151], v[48:51]
    v_mfma_f32_16x16x32_bf16 v[40:43], v[188:191], v[148:151], v[40:43]
    v_mfma_f32_16x16x32_bf16 v[40:43], v[180:183], v[144:147], v[40:43]
    v_mfma_f32_16x16x32_bf16 v[32:35], v[188:191], v[144:147], v[32:35]
    v_mfma_f32_16x16x32_bf16 v[32:35], v[180:183], v[140:143], v[32:35]
    v_mfma_f32_16x16x32_bf16 v[24:27], v[188:191], v[140:143], v[24:27]
    v_mfma_f32_16x16x32_bf16 v[24:27], v[180:183], v[136:139], v[24:27]
    v_mfma_f32_16x16x32_bf16 v[16:19], v[188:191], v[136:139], v[16:19]
    v_mfma_f32_16x16x32_bf16 v[16:19], v[180:183], v[132:135], v[16:19]
    v_mfma_f32_16x16x32_bf16 v[8:11], v[188:191], v[132:135], v[8:11]
    v_mfma_f32_16x16x32_bf16 v[8:11], v[180:183], v[128:131], v[8:11]
    s_waitcnt lgkmcnt(2)
    v_mfma_f32_16x16x32_bf16 v[8:11], v[164:167], v[72:75], v[8:11]
    ds_read_b64_tr_b16 v[180:181], v202 offset:8192
    v_mfma_f32_16x16x32_bf16 v[8:11], v[172:175], v[76:79], v[8:11]
    ds_read_b64_tr_b16 v[182:183], v202 offset:8704
    v_mfma_f32_16x16x32_bf16 v[16:19], v[164:167], v[76:79], v[16:19]
    ds_read_b64_tr_b16 v[188:189], v202 offset:12288
    v_mfma_f32_16x16x32_bf16 v[16:19], v[172:175], v[80:83], v[16:19]
    ds_read_b64_tr_b16 v[190:191], v202 offset:12800
    v_mfma_f32_16x16x32_bf16 v[24:27], v[164:167], v[80:83], v[24:27]
    ds_read_b64_tr_b16 v[184:185], v203 offset:8192
    v_mfma_f32_16x16x32_bf16 v[24:27], v[172:175], v[84:87], v[24:27]
    ds_read_b64_tr_b16 v[186:187], v203 offset:8704
    v_mfma_f32_16x16x32_bf16 v[32:35], v[164:167], v[84:87], v[32:35]
    ds_read_b64_tr_b16 v[192:193], v203 offset:12288
    v_mfma_f32_16x16x32_bf16 v[32:35], v[172:175], v[88:91], v[32:35]
    ds_read_b64_tr_b16 v[194:195], v203 offset:12800
    v_mfma_f32_16x16x32_bf16 v[40:43], v[164:167], v[88:91], v[40:43]
    ds_read_b128 v[128:131], v199 offset:26112
    v_mfma_f32_16x16x32_bf16 v[40:43], v[172:175], v[92:95], v[40:43]
    ds_read_b128 v[132:135], v199 offset:30464
    v_mfma_f32_16x16x32_bf16 v[48:51], v[164:167], v[92:95], v[48:51]
    ds_read_b128 v[136:139], v201 offset:0
    v_mfma_f32_16x16x32_bf16 v[48:51], v[172:175], v[96:99], v[48:51]
    ds_read_b128 v[140:143], v201 offset:4352
    v_mfma_f32_16x16x32_bf16 v[56:59], v[164:167], v[96:99], v[56:59]
    v_mfma_f32_16x16x32_bf16 v[56:59], v[172:175], v[100:103], v[56:59]
    v_mfma_f32_16x16x32_bf16 v[64:67], v[164:167], v[100:103], v[64:67]
    v_mfma_f32_16x16x32_bf16 v[64:67], v[172:175], v[104:107], v[64:67]
    v_mfma_f32_16x16x32_bf16 v[68:71], v[176:179], v[104:107], v[68:71]
    v_mfma_f32_16x16x32_bf16 v[68:71], v[168:171], v[100:103], v[68:71]
    v_mfma_f32_16x16x32_bf16 v[60:63], v[176:179], v[100:103], v[60:63]
    v_mfma_f32_16x16x32_bf16 v[60:63], v[168:171], v[96:99], v[60:63]
    v_mfma_f32_16x16x32_bf16 v[52:55], v[176:179], v[96:99], v[52:55]
    v_mfma_f32_16x16x32_bf16 v[52:55], v[168:171], v[92:95], v[52:55]
    v_mfma_f32_16x16x32_bf16 v[44:47], v[176:179], v[92:95], v[44:47]
    v_mfma_f32_16x16x32_bf16 v[44:47], v[168:171], v[88:91], v[44:47]
    v_mfma_f32_16x16x32_bf16 v[36:39], v[176:179], v[88:91], v[36:39]
    v_mfma_f32_16x16x32_bf16 v[36:39], v[168:171], v[84:87], v[36:39]
    v_mfma_f32_16x16x32_bf16 v[28:31], v[176:179], v[84:87], v[28:31]
    v_mfma_f32_16x16x32_bf16 v[28:31], v[168:171], v[80:83], v[28:31]
    v_mfma_f32_16x16x32_bf16 v[20:23], v[176:179], v[80:83], v[20:23]
    v_mfma_f32_16x16x32_bf16 v[20:23], v[168:171], v[76:79], v[20:23]
    v_mfma_f32_16x16x32_bf16 v[12:15], v[176:179], v[76:79], v[12:15]
    v_mfma_f32_16x16x32_bf16 v[12:15], v[168:171], v[72:75], v[12:15]
    s_waitcnt lgkmcnt(4)
    v_mfma_f32_16x16x32_bf16 v[12:15], v[184:187], v[80:83], v[12:15]
    s_barrier
    ds_read_b64_tr_b16 v[164:165], v202 offset:16384
    v_mfma_f32_16x16x32_bf16 v[12:15], v[192:195], v[84:87], v[12:15]
    ds_read_b64_tr_b16 v[166:167], v202 offset:16896
    v_mfma_f32_16x16x32_bf16 v[20:23], v[184:187], v[84:87], v[20:23]
    ds_read_b64_tr_b16 v[172:173], v202 offset:20480
    v_mfma_f32_16x16x32_bf16 v[20:23], v[192:195], v[88:91], v[20:23]
    ds_read_b64_tr_b16 v[174:175], v202 offset:20992
    v_mfma_f32_16x16x32_bf16 v[28:31], v[184:187], v[88:91], v[28:31]
    ds_read_b64_tr_b16 v[168:169], v203 offset:16384
    v_mfma_f32_16x16x32_bf16 v[28:31], v[192:195], v[92:95], v[28:31]
    ds_read_b64_tr_b16 v[170:171], v203 offset:16896
    v_mfma_f32_16x16x32_bf16 v[36:39], v[184:187], v[92:95], v[36:39]
    ds_read_b64_tr_b16 v[176:177], v203 offset:20480
    v_mfma_f32_16x16x32_bf16 v[36:39], v[192:195], v[96:99], v[36:39]
    ds_read_b64_tr_b16 v[178:179], v203 offset:20992
    v_mfma_f32_16x16x32_bf16 v[44:47], v[184:187], v[96:99], v[44:47]
    ds_read_b128 v[144:147], v201 offset:8704
    v_mfma_f32_16x16x32_bf16 v[44:47], v[192:195], v[100:103], v[44:47]
    ds_read_b128 v[148:151], v201 offset:13056
    v_mfma_f32_16x16x32_bf16 v[52:55], v[184:187], v[100:103], v[52:55]
    ds_read_b128 v[152:155], v201 offset:17408
    v_mfma_f32_16x16x32_bf16 v[52:55], v[192:195], v[104:107], v[52:55]
    v_mfma_f32_16x16x32_bf16 v[60:63], v[184:187], v[104:107], v[60:63]
    v_mfma_f32_16x16x32_bf16 v[60:63], v[192:195], v[108:111], v[60:63]
    v_mfma_f32_16x16x32_bf16 v[68:71], v[184:187], v[108:111], v[68:71]
    v_mfma_f32_16x16x32_bf16 v[68:71], v[192:195], v[112:115], v[68:71]
    v_mfma_f32_16x16x32_bf16 v[64:67], v[188:191], v[112:115], v[64:67]
    v_mfma_f32_16x16x32_bf16 v[64:67], v[180:183], v[108:111], v[64:67]
    v_mfma_f32_16x16x32_bf16 v[56:59], v[188:191], v[108:111], v[56:59]
    v_mfma_f32_16x16x32_bf16 v[56:59], v[180:183], v[104:107], v[56:59]
    v_mfma_f32_16x16x32_bf16 v[48:51], v[188:191], v[104:107], v[48:51]
    v_mfma_f32_16x16x32_bf16 v[48:51], v[180:183], v[100:103], v[48:51]
    v_mfma_f32_16x16x32_bf16 v[40:43], v[188:191], v[100:103], v[40:43]
    v_mfma_f32_16x16x32_bf16 v[40:43], v[180:183], v[96:99], v[40:43]
    v_mfma_f32_16x16x32_bf16 v[32:35], v[188:191], v[96:99], v[32:35]
    v_mfma_f32_16x16x32_bf16 v[32:35], v[180:183], v[92:95], v[32:35]
    v_mfma_f32_16x16x32_bf16 v[24:27], v[188:191], v[92:95], v[24:27]
    v_mfma_f32_16x16x32_bf16 v[24:27], v[180:183], v[88:91], v[24:27]
    v_mfma_f32_16x16x32_bf16 v[16:19], v[188:191], v[88:91], v[16:19]
    v_mfma_f32_16x16x32_bf16 v[16:19], v[180:183], v[84:87], v[16:19]
    v_mfma_f32_16x16x32_bf16 v[8:11], v[188:191], v[84:87], v[8:11]
    v_mfma_f32_16x16x32_bf16 v[8:11], v[180:183], v[80:83], v[8:11]
    s_waitcnt lgkmcnt(3)
    v_mfma_f32_16x16x32_bf16 v[8:11], v[164:167], v[88:91], v[8:11]
    ds_read_b64_tr_b16 v[180:181], v202 offset:24576
    v_mfma_f32_16x16x32_bf16 v[8:11], v[172:175], v[92:95], v[8:11]
    ds_read_b64_tr_b16 v[182:183], v202 offset:25088
    v_mfma_f32_16x16x32_bf16 v[16:19], v[164:167], v[92:95], v[16:19]
    ds_read_b64_tr_b16 v[188:189], v202 offset:28672
    v_mfma_f32_16x16x32_bf16 v[16:19], v[172:175], v[96:99], v[16:19]
    ds_read_b64_tr_b16 v[190:191], v202 offset:29184
    v_mfma_f32_16x16x32_bf16 v[24:27], v[164:167], v[96:99], v[24:27]
    ds_read_b64_tr_b16 v[184:185], v203 offset:24576
    v_mfma_f32_16x16x32_bf16 v[24:27], v[172:175], v[100:103], v[24:27]
    ds_read_b64_tr_b16 v[186:187], v203 offset:25088
    v_mfma_f32_16x16x32_bf16 v[32:35], v[164:167], v[100:103], v[32:35]
    ds_read_b64_tr_b16 v[192:193], v203 offset:28672
    v_mfma_f32_16x16x32_bf16 v[32:35], v[172:175], v[104:107], v[32:35]
    ds_read_b64_tr_b16 v[194:195], v203 offset:29184
    v_mfma_f32_16x16x32_bf16 v[40:43], v[164:167], v[104:107], v[40:43]
    ds_read_b128 v[156:159], v201 offset:21760
    v_mfma_f32_16x16x32_bf16 v[40:43], v[172:175], v[108:111], v[40:43]
    ds_read_b128 v[160:163], v201 offset:26112
    v_mfma_f32_16x16x32_bf16 v[48:51], v[164:167], v[108:111], v[48:51]
    v_mfma_f32_16x16x32_bf16 v[48:51], v[172:175], v[112:115], v[48:51]
    v_mfma_f32_16x16x32_bf16 v[56:59], v[164:167], v[112:115], v[56:59]
    v_mfma_f32_16x16x32_bf16 v[56:59], v[172:175], v[116:119], v[56:59]
    v_mfma_f32_16x16x32_bf16 v[64:67], v[164:167], v[116:119], v[64:67]
    v_mfma_f32_16x16x32_bf16 v[64:67], v[172:175], v[120:123], v[64:67]
    v_mfma_f32_16x16x32_bf16 v[68:71], v[176:179], v[120:123], v[68:71]
    v_mfma_f32_16x16x32_bf16 v[68:71], v[168:171], v[116:119], v[68:71]
    v_mfma_f32_16x16x32_bf16 v[60:63], v[176:179], v[116:119], v[60:63]
    v_mfma_f32_16x16x32_bf16 v[60:63], v[168:171], v[112:115], v[60:63]
    v_mfma_f32_16x16x32_bf16 v[52:55], v[176:179], v[112:115], v[52:55]
    v_mfma_f32_16x16x32_bf16 v[52:55], v[168:171], v[108:111], v[52:55]
    v_mfma_f32_16x16x32_bf16 v[44:47], v[176:179], v[108:111], v[44:47]
    v_mfma_f32_16x16x32_bf16 v[44:47], v[168:171], v[104:107], v[44:47]
    v_mfma_f32_16x16x32_bf16 v[36:39], v[176:179], v[104:107], v[36:39]
    v_mfma_f32_16x16x32_bf16 v[36:39], v[168:171], v[100:103], v[36:39]
    v_mfma_f32_16x16x32_bf16 v[28:31], v[176:179], v[100:103], v[28:31]
    v_mfma_f32_16x16x32_bf16 v[28:31], v[168:171], v[96:99], v[28:31]
    v_mfma_f32_16x16x32_bf16 v[20:23], v[176:179], v[96:99], v[20:23]
    v_mfma_f32_16x16x32_bf16 v[20:23], v[168:171], v[92:95], v[20:23]
    v_mfma_f32_16x16x32_bf16 v[12:15], v[176:179], v[92:95], v[12:15]
    v_mfma_f32_16x16x32_bf16 v[12:15], v[168:171], v[88:91], v[12:15]
    s_waitcnt lgkmcnt(2)
    v_mfma_f32_16x16x32_bf16 v[12:15], v[184:187], v[96:99], v[12:15]
    s_barrier
    ds_read_b64_tr_b16 v[164:165], v202 offset:32768
    v_mfma_f32_16x16x32_bf16 v[12:15], v[192:195], v[100:103], v[12:15]
    ds_read_b64_tr_b16 v[166:167], v202 offset:33280
    v_mfma_f32_16x16x32_bf16 v[20:23], v[184:187], v[100:103], v[20:23]
    ds_read_b64_tr_b16 v[172:173], v202 offset:36864
    v_mfma_f32_16x16x32_bf16 v[20:23], v[192:195], v[104:107], v[20:23]
    ds_read_b64_tr_b16 v[174:175], v202 offset:37376
    v_mfma_f32_16x16x32_bf16 v[28:31], v[184:187], v[104:107], v[28:31]
    ds_read_b64_tr_b16 v[168:169], v203 offset:32768
    v_mfma_f32_16x16x32_bf16 v[28:31], v[192:195], v[108:111], v[28:31]
    ds_read_b64_tr_b16 v[170:171], v203 offset:33280
    v_mfma_f32_16x16x32_bf16 v[36:39], v[184:187], v[108:111], v[36:39]
    ds_read_b64_tr_b16 v[176:177], v203 offset:36864
    v_mfma_f32_16x16x32_bf16 v[36:39], v[192:195], v[112:115], v[36:39]
    ds_read_b64_tr_b16 v[178:179], v203 offset:37376
    v_mfma_f32_16x16x32_bf16 v[44:47], v[184:187], v[112:115], v[44:47]
    ds_read_b128 v[72:75], v196 offset:34816
    v_mfma_f32_16x16x32_bf16 v[44:47], v[192:195], v[116:119], v[44:47]
    ds_read_b128 v[76:79], v196 offset:39168
    v_mfma_f32_16x16x32_bf16 v[52:55], v[184:187], v[116:119], v[52:55]
    ds_read_b128 v[80:83], v196 offset:43520
    v_mfma_f32_16x16x32_bf16 v[52:55], v[192:195], v[120:123], v[52:55]
    ds_read_b128 v[84:87], v196 offset:47872
    v_mfma_f32_16x16x32_bf16 v[60:63], v[184:187], v[120:123], v[60:63]
    v_mfma_f32_16x16x32_bf16 v[60:63], v[192:195], v[124:127], v[60:63]
    v_mfma_f32_16x16x32_bf16 v[68:71], v[184:187], v[124:127], v[68:71]
    v_mfma_f32_16x16x32_bf16 v[68:71], v[192:195], v[128:131], v[68:71]
    v_mfma_f32_16x16x32_bf16 v[64:67], v[188:191], v[128:131], v[64:67]
    v_mfma_f32_16x16x32_bf16 v[64:67], v[180:183], v[124:127], v[64:67]
    v_mfma_f32_16x16x32_bf16 v[56:59], v[188:191], v[124:127], v[56:59]
    v_mfma_f32_16x16x32_bf16 v[56:59], v[180:183], v[120:123], v[56:59]
    v_mfma_f32_16x16x32_bf16 v[48:51], v[188:191], v[120:123], v[48:51]
    v_mfma_f32_16x16x32_bf16 v[48:51], v[180:183], v[116:119], v[48:51]
    v_mfma_f32_16x16x32_bf16 v[40:43], v[188:191], v[116:119], v[40:43]
    v_mfma_f32_16x16x32_bf16 v[40:43], v[180:183], v[112:115], v[40:43]
    v_mfma_f32_16x16x32_bf16 v[32:35], v[188:191], v[112:115], v[32:35]
    v_mfma_f32_16x16x32_bf16 v[32:35], v[180:183], v[108:111], v[32:35]
    v_mfma_f32_16x16x32_bf16 v[24:27], v[188:191], v[108:111], v[24:27]
    v_mfma_f32_16x16x32_bf16 v[24:27], v[180:183], v[104:107], v[24:27]
    v_mfma_f32_16x16x32_bf16 v[16:19], v[188:191], v[104:107], v[16:19]
    v_mfma_f32_16x16x32_bf16 v[16:19], v[180:183], v[100:103], v[16:19]
    v_mfma_f32_16x16x32_bf16 v[8:11], v[188:191], v[100:103], v[8:11]
    v_mfma_f32_16x16x32_bf16 v[8:11], v[180:183], v[96:99], v[8:11]
    s_waitcnt lgkmcnt(4)
    v_mfma_f32_16x16x32_bf16 v[8:11], v[164:167], v[104:107], v[8:11]
    ds_read_b64_tr_b16 v[180:181], v202 offset:40960
    v_mfma_f32_16x16x32_bf16 v[8:11], v[172:175], v[108:111], v[8:11]
    ds_read_b64_tr_b16 v[182:183], v202 offset:41472
    v_mfma_f32_16x16x32_bf16 v[16:19], v[164:167], v[108:111], v[16:19]
    ds_read_b64_tr_b16 v[188:189], v202 offset:45056
    v_mfma_f32_16x16x32_bf16 v[16:19], v[172:175], v[112:115], v[16:19]
    ds_read_b64_tr_b16 v[190:191], v202 offset:45568
    v_mfma_f32_16x16x32_bf16 v[24:27], v[164:167], v[112:115], v[24:27]
    ds_read_b64_tr_b16 v[184:185], v203 offset:40960
    v_mfma_f32_16x16x32_bf16 v[24:27], v[172:175], v[116:119], v[24:27]
    ds_read_b64_tr_b16 v[186:187], v203 offset:41472
    v_mfma_f32_16x16x32_bf16 v[32:35], v[164:167], v[116:119], v[32:35]
    ds_read_b64_tr_b16 v[192:193], v203 offset:45056
    v_mfma_f32_16x16x32_bf16 v[32:35], v[172:175], v[120:123], v[32:35]
    ds_read_b64_tr_b16 v[194:195], v203 offset:45568
    v_mfma_f32_16x16x32_bf16 v[40:43], v[164:167], v[120:123], v[40:43]
    ds_read_b128 v[88:91], v196 offset:52224
    v_mfma_f32_16x16x32_bf16 v[40:43], v[172:175], v[124:127], v[40:43]
    ds_read_b128 v[92:95], v196 offset:56576
    v_mfma_f32_16x16x32_bf16 v[48:51], v[164:167], v[124:127], v[48:51]
    ds_read_b128 v[96:99], v196 offset:60928
    v_mfma_f32_16x16x32_bf16 v[48:51], v[172:175], v[128:131], v[48:51]
    v_mfma_f32_16x16x32_bf16 v[56:59], v[164:167], v[128:131], v[56:59]
    v_mfma_f32_16x16x32_bf16 v[56:59], v[172:175], v[132:135], v[56:59]
    v_mfma_f32_16x16x32_bf16 v[64:67], v[164:167], v[132:135], v[64:67]
    v_mfma_f32_16x16x32_bf16 v[64:67], v[172:175], v[136:139], v[64:67]
    v_mfma_f32_16x16x32_bf16 v[68:71], v[176:179], v[136:139], v[68:71]
    v_mfma_f32_16x16x32_bf16 v[68:71], v[168:171], v[132:135], v[68:71]
    v_mfma_f32_16x16x32_bf16 v[60:63], v[176:179], v[132:135], v[60:63]
    v_mfma_f32_16x16x32_bf16 v[60:63], v[168:171], v[128:131], v[60:63]
    v_mfma_f32_16x16x32_bf16 v[52:55], v[176:179], v[128:131], v[52:55]
    v_mfma_f32_16x16x32_bf16 v[52:55], v[168:171], v[124:127], v[52:55]
    v_mfma_f32_16x16x32_bf16 v[44:47], v[176:179], v[124:127], v[44:47]
    v_mfma_f32_16x16x32_bf16 v[44:47], v[168:171], v[120:123], v[44:47]
    v_mfma_f32_16x16x32_bf16 v[36:39], v[176:179], v[120:123], v[36:39]
    v_mfma_f32_16x16x32_bf16 v[36:39], v[168:171], v[116:119], v[36:39]
    v_mfma_f32_16x16x32_bf16 v[28:31], v[176:179], v[116:119], v[28:31]
    v_mfma_f32_16x16x32_bf16 v[28:31], v[168:171], v[112:115], v[28:31]
    v_mfma_f32_16x16x32_bf16 v[20:23], v[176:179], v[112:115], v[20:23]
    v_mfma_f32_16x16x32_bf16 v[20:23], v[168:171], v[108:111], v[20:23]
    v_mfma_f32_16x16x32_bf16 v[12:15], v[176:179], v[108:111], v[12:15]
    v_mfma_f32_16x16x32_bf16 v[12:15], v[168:171], v[104:107], v[12:15]
    s_waitcnt lgkmcnt(3)
    v_mfma_f32_16x16x32_bf16 v[12:15], v[184:187], v[112:115], v[12:15]
    s_barrier
    ds_read_b64_tr_b16 v[164:165], v202 offset:49152
    v_mfma_f32_16x16x32_bf16 v[12:15], v[192:195], v[116:119], v[12:15]
    ds_read_b64_tr_b16 v[166:167], v202 offset:49664
    v_mfma_f32_16x16x32_bf16 v[20:23], v[184:187], v[116:119], v[20:23]
    ds_read_b64_tr_b16 v[172:173], v202 offset:53248
    v_mfma_f32_16x16x32_bf16 v[20:23], v[192:195], v[120:123], v[20:23]
    ds_read_b64_tr_b16 v[174:175], v202 offset:53760
    v_mfma_f32_16x16x32_bf16 v[28:31], v[184:187], v[120:123], v[28:31]
    ds_read_b64_tr_b16 v[168:169], v203 offset:49152
    v_mfma_f32_16x16x32_bf16 v[28:31], v[192:195], v[124:127], v[28:31]
    ds_read_b64_tr_b16 v[170:171], v203 offset:49664
    v_mfma_f32_16x16x32_bf16 v[36:39], v[184:187], v[124:127], v[36:39]
    ds_read_b64_tr_b16 v[176:177], v203 offset:53248
    v_mfma_f32_16x16x32_bf16 v[36:39], v[192:195], v[128:131], v[36:39]
    ds_read_b64_tr_b16 v[178:179], v203 offset:53760
    v_mfma_f32_16x16x32_bf16 v[44:47], v[184:187], v[128:131], v[44:47]
    ds_read_b128 v[100:103], v196 offset:65280
    v_mfma_f32_16x16x32_bf16 v[44:47], v[192:195], v[132:135], v[44:47]
    ds_read_b128 v[104:107], v198 offset:34816
    v_mfma_f32_16x16x32_bf16 v[52:55], v[184:187], v[132:135], v[52:55]
    v_mfma_f32_16x16x32_bf16 v[52:55], v[192:195], v[136:139], v[52:55]
    v_mfma_f32_16x16x32_bf16 v[60:63], v[184:187], v[136:139], v[60:63]
    v_mfma_f32_16x16x32_bf16 v[60:63], v[192:195], v[140:143], v[60:63]
    v_mfma_f32_16x16x32_bf16 v[68:71], v[184:187], v[140:143], v[68:71]
    v_mfma_f32_16x16x32_bf16 v[68:71], v[192:195], v[144:147], v[68:71]
    v_mfma_f32_16x16x32_bf16 v[64:67], v[188:191], v[144:147], v[64:67]
    v_mfma_f32_16x16x32_bf16 v[64:67], v[180:183], v[140:143], v[64:67]
    v_mfma_f32_16x16x32_bf16 v[56:59], v[188:191], v[140:143], v[56:59]
    v_mfma_f32_16x16x32_bf16 v[56:59], v[180:183], v[136:139], v[56:59]
    v_mfma_f32_16x16x32_bf16 v[48:51], v[188:191], v[136:139], v[48:51]
    v_mfma_f32_16x16x32_bf16 v[48:51], v[180:183], v[132:135], v[48:51]
    v_mfma_f32_16x16x32_bf16 v[40:43], v[188:191], v[132:135], v[40:43]
    v_mfma_f32_16x16x32_bf16 v[40:43], v[180:183], v[128:131], v[40:43]
    v_mfma_f32_16x16x32_bf16 v[32:35], v[188:191], v[128:131], v[32:35]
    v_mfma_f32_16x16x32_bf16 v[32:35], v[180:183], v[124:127], v[32:35]
    v_mfma_f32_16x16x32_bf16 v[24:27], v[188:191], v[124:127], v[24:27]
    v_mfma_f32_16x16x32_bf16 v[24:27], v[180:183], v[120:123], v[24:27]
    v_mfma_f32_16x16x32_bf16 v[16:19], v[188:191], v[120:123], v[16:19]
    v_mfma_f32_16x16x32_bf16 v[16:19], v[180:183], v[116:119], v[16:19]
    v_mfma_f32_16x16x32_bf16 v[8:11], v[188:191], v[116:119], v[8:11]
    v_mfma_f32_16x16x32_bf16 v[8:11], v[180:183], v[112:115], v[8:11]
    s_waitcnt lgkmcnt(2)
    v_mfma_f32_16x16x32_bf16 v[8:11], v[164:167], v[120:123], v[8:11]
    ds_read_b64_tr_b16 v[180:181], v202 offset:57344
    v_mfma_f32_16x16x32_bf16 v[8:11], v[172:175], v[124:127], v[8:11]
    ds_read_b64_tr_b16 v[182:183], v202 offset:57856
    v_mfma_f32_16x16x32_bf16 v[16:19], v[164:167], v[124:127], v[16:19]
    ds_read_b64_tr_b16 v[188:189], v202 offset:61440
    v_mfma_f32_16x16x32_bf16 v[16:19], v[172:175], v[128:131], v[16:19]
    ds_read_b64_tr_b16 v[190:191], v202 offset:61952
    v_mfma_f32_16x16x32_bf16 v[24:27], v[164:167], v[128:131], v[24:27]
    ds_read_b64_tr_b16 v[184:185], v203 offset:57344
    v_mfma_f32_16x16x32_bf16 v[24:27], v[172:175], v[132:135], v[24:27]
    ds_read_b64_tr_b16 v[186:187], v203 offset:57856
    v_mfma_f32_16x16x32_bf16 v[32:35], v[164:167], v[132:135], v[32:35]
    ds_read_b64_tr_b16 v[192:193], v203 offset:61440
    v_mfma_f32_16x16x32_bf16 v[32:35], v[172:175], v[136:139], v[32:35]
    ds_read_b64_tr_b16 v[194:195], v203 offset:61952
    v_mfma_f32_16x16x32_bf16 v[40:43], v[164:167], v[136:139], v[40:43]
    ds_read_b128 v[108:111], v198 offset:39168
    v_mfma_f32_16x16x32_bf16 v[40:43], v[172:175], v[140:143], v[40:43]
    ds_read_b128 v[112:115], v198 offset:43520
    v_mfma_f32_16x16x32_bf16 v[48:51], v[164:167], v[140:143], v[48:51]
    v_mfma_f32_16x16x32_bf16 v[48:51], v[172:175], v[144:147], v[48:51]
    v_mfma_f32_16x16x32_bf16 v[56:59], v[164:167], v[144:147], v[56:59]
    v_mfma_f32_16x16x32_bf16 v[56:59], v[172:175], v[148:151], v[56:59]
    v_mfma_f32_16x16x32_bf16 v[64:67], v[164:167], v[148:151], v[64:67]
    v_mfma_f32_16x16x32_bf16 v[64:67], v[172:175], v[152:155], v[64:67]
    v_mfma_f32_16x16x32_bf16 v[68:71], v[176:179], v[152:155], v[68:71]
    v_mfma_f32_16x16x32_bf16 v[68:71], v[168:171], v[148:151], v[68:71]
    v_mfma_f32_16x16x32_bf16 v[60:63], v[176:179], v[148:151], v[60:63]
    v_mfma_f32_16x16x32_bf16 v[60:63], v[168:171], v[144:147], v[60:63]
    v_mfma_f32_16x16x32_bf16 v[52:55], v[176:179], v[144:147], v[52:55]
    v_mfma_f32_16x16x32_bf16 v[52:55], v[168:171], v[140:143], v[52:55]
    v_mfma_f32_16x16x32_bf16 v[44:47], v[176:179], v[140:143], v[44:47]
    v_mfma_f32_16x16x32_bf16 v[44:47], v[168:171], v[136:139], v[44:47]
    s_branch L_over1
L_pad1:
    s_branch L_hopped
L_over1:
    v_mfma_f32_16x16x32_bf16 v[36:39], v[176:179], v[136:139], v[36:39]
    v_mfma_f32_16x16x32_bf16 v[36:39], v[168:171], v[132:135], v[36:39]
    v_mfma_f32_16x16x32_bf16 v[28:31], v[176:179], v[132:135], v[28:31]
    v_mfma_f32_16x16x32_bf16 v[28:31], v[168:171], v[128:131], v[28:31]
    v_mfma_f32_16x16x32_bf16 v[20:23], v[176:179], v[128:131], v[20:23]
    v_mfma_f32_16x16x32_bf16 v[20:23], v[168:171], v[124:127], v[20:23]
    v_mfma_f32_16x16x32_bf16 v[12:15], v[176:179], v[124:127], v[12:15]
    v_mfma_f32_16x16x32_bf16 v[12:15], v[168:171], v[120:123], v[12:15]
    s_waitcnt lgkmcnt(2)
    v_mfma_f32_16x16x32_bf16 v[12:15], v[184:187], v[128:131], v[12:15]
    s_barrier
    ds_read_b64_tr_b16 v[164:165], v204 offset:0
    v_mfma_f32_16x16x32_bf16 v[12:15], v[192:195], v[132:135], v[12:15]
    ds_read_b64_tr_b16 v[166:167], v204 offset:512
    v_mfma_f32_16x16x32_bf16 v[20:23], v[184:187], v[132:135], v[20:23]
    ds_read_b64_tr_b16 v[172:173], v204 offset:4096
    v_mfma_f32_16x16x32_bf16 v[20:23], v[192:195], v[136:139], v[20:23]
    ds_read_b64_tr_b16 v[174:175], v204 offset:4608
    v_mfma_f32_16x16x32_bf16 v[28:31], v[184:187], v[136:139], v[28:31]
    ds_read_b64_tr_b16 v[168:169], v205 offset:0
    v_mfma_f32_16x16x32_bf16 v[28:31], v[192:195], v[140:143], v[28:31]
    ds_read_b64_tr_b16 v[170:171], v205 offset:512
    v_mfma_f32_16x16x32_bf16 v[36:39], v[184:187], v[140:143], v[36:39]
    ds_read_b64_tr_b16 v[176:177], v205 offset:4096
    v_mfma_f32_16x16x32_bf16 v[36:39], v[192:195], v[144:147], v[36:39]
    ds_read_b64_tr_b16 v[178:179], v205 offset:4608
    v_mfma_f32_16x16x32_bf16 v[44:47], v[184:187], v[144:147], v[44:47]
    ds_read_b128 v[116:119], v198 offset:47872
    v_mfma_f32_16x16x32_bf16 v[44:47], v[192:195], v[148:151], v[44:47]
    ds_read_b128 v[120:123], v198 offset:52224
    v_mfma_f32_16x16x32_bf16 v[52:55], v[184:187], v[148:151], v[52:55]
    v_mfma_f32_16x16x32_bf16 v[52:55], v[192:195], v[152:155], v[52:55]
    v_mfma_f32_16x16x32_bf16 v[60:63], v[184:187], v[152:155], v[60:63]
    v_mfma_f32_16x16x32_bf16 v[60:63], v[192:195], v[156:159], v[60:63]
    v_mfma_f32_16x16x32_bf16 v[68:71], v[184:187], v[156:159], v[68:71]
    v_mfma_f32_16x16x32_bf16 v[68:71], v[192:195], v[160:163], v[68:71]
    v_mfma_f32_16x16x32_bf16 v[64:67], v[188:191], v[160:163], v[64:67]
    v_mfma_f32_16x16x32_bf16 v[64:67], v[180:183], v[156:159], v[64:67]
    v_mfma_f32_16x16x32_bf16 v[56:59], v[188:191], v[156:159], v[56:59]
    v_mfma_f32_16x16x32_bf16 v[56:59], v[180:183], v[152:155], v[56:59]
    v_mfma_f32_16x16x32_bf16 v[48:51], v[188:191], v[152:155], v[48:51]
    v_mfma_f32_16x16x32_bf16 v[48:51], v[180:183], v[148:151], v[48:51]
    v_mfma_f32_16x16x32_bf16 v[40:43], v[188:191], v[148:151], v[40:43]
    v_mfma_f32_16x16x32_bf16 v[40:43], v[180:183], v[144:147], v[40:43]
    v_mfma_f32_16x16x32_bf16 v[32:35], v[188:191], v[144:147], v[32:35]
    v_mfma_f32_16x16x32_bf16 v[32:35], v[180:183], v[140:143], v[32:35]
    v_mfma_f32_16x16x32_bf16 v[24:27], v[188:191], v[140:143], v[24:27]
    v_mfma_f32_16x16x32_bf16 v[24:27], v[180:183], v[136:139], v[24:27]
    v_mfma_f32_16x16x32_bf16 v[16:19], v[188:191], v[136:139], v[16:19]
    v_mfma_f32_16x16x32_bf16 v[16:19], v[180:183], v[132:135], v[16:19]
    v_mfma_f32_16x16x32_bf16 v[8:11], v[188:191], v[132:135], v[8:11]
    v_mfma_f32_16x16x32_bf16 v[8:11], v[180:183], v[128:131], v[8:11]
    s_waitcnt lgkmcnt(2)
    v_mfma_f32_16x16x32_bf16 v[8:11], v[164:167], v[72:75], v[8:11]
    ds_read_b64_tr_b16 v[180:181], v204 offset:8192
    v_mfma_f32_16x16x32_bf16 v[8:11], v[172:175], v[76:79], v[8:11]
    ds_read_b64_tr_b16 v[182:183], v204 offset:8704
    v_mfma_f32_16x16x32_bf16 v[16:19], v[164:167], v[76:79], v[16:19]
    ds_read_b64_tr_b16 v[188:189], v204 offset:12288
    v_mfma_f32_16x16x32_bf16 v[16:19], v[172:175], v[80:83], v[16:19]
    ds_read_b64_tr_b16 v[190:191], v204 offset:12800
    v_mfma_f32_16x16x32_bf16 v[24:27], v[164:167], v[80:83], v[24:27]
    ds_read_b64_tr_b16 v[184:185], v205 offset:8192
    v_mfma_f32_16x16x32_bf16 v[24:27], v[172:175], v[84:87], v[24:27]
    ds_read_b64_tr_b16 v[186:187], v205 offset:8704
    v_mfma_f32_16x16x32_bf16 v[32:35], v[164:167], v[84:87], v[32:35]
    ds_read_b64_tr_b16 v[192:193], v205 offset:12288
    v_mfma_f32_16x16x32_bf16 v[32:35], v[172:175], v[88:91], v[32:35]
    ds_read_b64_tr_b16 v[194:195], v205 offset:12800
    v_mfma_f32_16x16x32_bf16 v[36:39], v[176:179], v[88:91], v[36:39]
    ds_read_b128 v[124:127], v198 offset:56576
    v_mfma_f32_16x16x32_bf16 v[36:39], v[168:171], v[84:87], v[36:39]
    ds_read_b128 v[128:131], v198 offset:60928
    v_mfma_f32_16x16x32_bf16 v[28:31], v[176:179], v[84:87], v[28:31]
    v_mfma_f32_16x16x32_bf16 v[28:31], v[168:171], v[80:83], v[28:31]
    v_mfma_f32_16x16x32_bf16 v[20:23], v[176:179], v[80:83], v[20:23]
    v_mfma_f32_16x16x32_bf16 v[20:23], v[168:171], v[76:79], v[20:23]
    v_mfma_f32_16x16x32_bf16 v[12:15], v[176:179], v[76:79], v[12:15]
    v_mfma_f32_16x16x32_bf16 v[12:15], v[168:171], v[72:75], v[12:15]
    s_waitcnt lgkmcnt(2)
    v_mfma_f32_16x16x32_bf16 v[12:15], v[184:187], v[80:83], v[12:15]
    ds_read_b64_tr_b16 v[164:165], v204 offset:16384
    v_mfma_f32_16x16x32_bf16 v[12:15], v[192:195], v[84:87], v[12:15]
    ds_read_b64_tr_b16 v[166:167], v204 offset:16896
    v_mfma_f32_16x16x32_bf16 v[20:23], v[184:187], v[84:87], v[20:23]
    ds_read_b64_tr_b16 v[172:173], v204 offset:20480
    v_mfma_f32_16x16x32_bf16 v[20:23], v[192:195], v[88:91], v[20:23]
    ds_read_b64_tr_b16 v[174:175], v204 offset:20992
    v_mfma_f32_16x16x32_bf16 v[28:31], v[184:187], v[88:91], v[28:31]
    ds_read_b64_tr_b16 v[168:169], v205 offset:16384
    v_mfma_f32_16x16x32_bf16 v[28:31], v[192:195], v[92:95], v[28:31]
    ds_read_b64_tr_b16 v[170:171], v205 offset:16896
    v_mfma_f32_16x16x32_bf16 v[36:39], v[184:187], v[92:95], v[36:39]
    ds_read_b64_tr_b16 v[176:177], v205 offset:20480
    v_mfma_f32_16x16x32_bf16 v[36:39], v[192:195], v[96:99], v[36:39]
    ds_read_b64_tr_b16 v[178:179], v205 offset:20992
    v_mfma_f32_16x16x32_bf16 v[32:35], v[188:191], v[96:99], v[32:35]
    ds_read_b128 v[132:135], v198 offset:65280
    v_mfma_f32_16x16x32_bf16 v[32:35], v[180:183], v[92:95], v[32:35]
    ds_read_b128 v[136:139], v200 offset:34816
    v_mfma_f32_16x16x32_bf16 v[24:27], v[188:191], v[92:95], v[24:27]
    v_mfma_f32_16x16x32_bf16 v[24:27], v[180:183], v[88:91], v[24:27]
    v_mfma_f32_16x16x32_bf16 v[16:19], v[188:191], v[88:91], v[16:19]
    v_mfma_f32_16x16x32_bf16 v[16:19], v[180:183], v[84:87], v[16:19]
    v_mfma_f32_16x16x32_bf16 v[8:11], v[188:191], v[84:87], v[8:11]
    v_mfma_f32_16x16x32_bf16 v[8:11], v[180:183], v[80:83], v[8:11]
    s_waitcnt lgkmcnt(2)
    v_mfma_f32_16x16x32_bf16 v[8:11], v[164:167], v[88:91], v[8:11]
    s_barrier
    ds_read_b64_tr_b16 v[180:181], v202 offset:0
    v_mfma_f32_16x16x32_bf16 v[8:11], v[172:175], v[92:95], v[8:11]
    ds_read_b64_tr_b16 v[182:183], v202 offset:512
    v_mfma_f32_16x16x32_bf16 v[16:19], v[164:167], v[92:95], v[16:19]
    ds_read_b64_tr_b16 v[188:189], v202 offset:4096
    v_mfma_f32_16x16x32_bf16 v[16:19], v[172:175], v[96:99], v[16:19]
    ds_read_b64_tr_b16 v[190:191], v202 offset:4608
    v_mfma_f32_16x16x32_bf16 v[24:27], v[164:167], v[96:99], v[24:27]
    ds_read_b64_tr_b16 v[184:185], v203 offset:0
    v_mfma_f32_16x16x32_bf16 v[24:27], v[172:175], v[100:103], v[24:27]
    ds_read_b64_tr_b16 v[186:187], v203 offset:512
    v_mfma_f32_16x16x32_bf16 v[32:35], v[164:167], v[100:103], v[32:35]
    ds_read_b64_tr_b16 v[192:193], v203 offset:4096
    v_mfma_f32_16x16x32_bf16 v[32:35], v[172:175], v[104:107], v[32:35]
    ds_read_b64_tr_b16 v[194:195], v203 offset:4608
    v_mfma_f32_16x16x32_bf16 v[36:39], v[176:179], v[104:107], v[36:39]
    ds_read_b128 v[140:143], v200 offset:39168
    v_mfma_f32_16x16x32_bf16 v[36:39], v[168:171], v[100:103], v[36:39]
    v_mfma_f32_16x16x32_bf16 v[28:31], v[176:179], v[100:103], v[28:31]
    v_mfma_f32_16x16x32_bf16 v[28:31], v[168:171], v[96:99], v[28:31]
    v_mfma_f32_16x16x32_bf16 v[20:23], v[176:179], v[96:99], v[20:23]
    v_mfma_f32_16x16x32_bf16 v[20:23], v[168:171], v[92:95], v[20:23]
    v_mfma_f32_16x16x32_bf16 v[12:15], v[176:179], v[92:95], v[12:15]
    v_mfma_f32_16x16x32_bf16 v[12:15], v[168:171], v[88:91], v[12:15]
    s_waitcnt lgkmcnt(1)
    v_mfma_f32_16x16x32_bf16 v[12:15], v[184:187], v[96:99], v[12:15]
    ds_read_b64_tr_b16 v[164:165], v202 offset:8192
    v_mfma_f32_16x16x32_bf16 v[12:15], v[192:195], v[100:103], v[12:15]
    ds_read_b64_tr_b16 v[166:167], v202 offset:8704
    v_mfma_f32_16x16x32_bf16 v[20:23], v[184:187], v[100:103], v[20:23]
    ds_read_b64_tr_b16 v[172:173], v202 offset:12288
    v_mfma_f32_16x16x32_bf16 v[20:23], v[192:195], v[104:107], v[20:23]
    ds_read_b64_tr_b16 v[174:175], v202 offset:12800
    v_mfma_f32_16x16x32_bf16 v[28:31], v[184:187], v[104:107], v[28:31]
    ds_read_b64_tr_b16 v[168:169], v203 offset:8192
    v_mfma_f32_16x16x32_bf16 v[28:31], v[192:195], v[108:111], v[28:31]
    ds_read_b64_tr_b16 v[170:171], v203 offset:8704
    v_mfma_f32_16x16x32_bf16 v[36:39], v[184:187], v[108:111], v[36:39]
    ds_read_b64_tr_b16 v[176:177], v203 offset:12288
    v_mfma_f32_16x16x32_bf16 v[36:39], v[192:195], v[112:115], v[36:39]
    ds_read_b64_tr_b16 v[178:179], v203 offset:12800
    v_mfma_f32_16x16x32_bf16 v[32:35], v[188:191], v[112:115], v[32:35]
    ds_read_b128 v[72:75], v197 offset:34816
    v_mfma_f32_16x16x32_bf16 v[32:35], v[180:183], v[108:111], v[32:35]
    ds_read_b128 v[76:79], v197 offset:39168
    v_mfma_f32_16x16x32_bf16 v[24:27], v[188:191], v[108:111], v[24:27]
    ds_read_b128 v[80:83], v197 offset:43520
    v_mfma_f32_16x16x32_bf16 v[24:27], v[180:183], v[104:107], v[24:27]
    ds_read_b128 v[84:87], v197 offset:47872
    v_mfma_f32_16x16x32_bf16 v[16:19], v[188:191], v[104:107], v[16:19]
    v_mfma_f32_16x16x32_bf16 v[16:19], v[180:183], v[100:103], v[16:19]
    v_mfma_f32_16x16x32_bf16 v[8:11], v[188:191], v[100:103], v[8:11]
    v_mfma_f32_16x16x32_bf16 v[8:11], v[180:183], v[96:99], v[8:11]
    s_waitcnt lgkmcnt(4)
    v_mfma_f32_16x16x32_bf16 v[8:11], v[164:167], v[104:107], v[8:11]
    ds_read_b64_tr_b16 v[180:181], v202 offset:16384
    v_mfma_f32_16x16x32_bf16 v[8:11], v[172:175], v[108:111], v[8:11]
    ds_read_b64_tr_b16 v[182:183], v202 offset:16896
    v_mfma_f32_16x16x32_bf16 v[16:19], v[164:167], v[108:111], v[16:19]
    ds_read_b64_tr_b16 v[188:189], v202 offset:20480
    v_mfma_f32_16x16x32_bf16 v[16:19], v[172:175], v[112:115], v[16:19]
    ds_read_b64_tr_b16 v[190:191], v202 offset:20992
    v_mfma_f32_16x16x32_bf16 v[24:27], v[164:167], v[112:115], v[24:27]
    ds_read_b64_tr_b16 v[184:185], v203 offset:16384
    v_mfma_f32_16x16x32_bf16 v[24:27], v[172:175], v[116:119], v[24:27]
    ds_read_b64_tr_b16 v[186:187], v203 offset:16896
    v_mfma_f32_16x16x32_bf16 v[32:35], v[164:167], v[116:119], v[32:35]
    ds_read_b64_tr_b16 v[192:193], v203 offset:20480
    v_mfma_f32_16x16x32_bf16 v[32:35], v[172:175], v[120:123], v[32:35]
    ds_read_b64_tr_b16 v[194:195], v203 offset:20992
    v_mfma_f32_16x16x32_bf16 v[36:39], v[176:179], v[120:123], v[36:39]
    ds_read_b128 v[88:91], v197 offset:52224
    v_mfma_f32_16x16x32_bf16 v[36:39], v[168:171], v[116:119], v[36:39]
    ds_read_b128 v[92:95], v197 offset:56576
    v_mfma_f32_16x16x32_bf16 v[28:31], v[176:179], v[116:119], v[28:31]
    ds_read_b128 v[96:99], v197 offset:60928
    v_mfma_f32_16x16x32_bf16 v[28:31], v[168:171], v[112:115], v[28:31]
    v_mfma_f32_16x16x32_bf16 v[20:23], v[176:179], v[112:115], v[20:23]
    v_mfma_f32_16x16x32_bf16 v[20:23], v[168:171], v[108:111], v[20:23]
    v_mfma_f32_16x16x32_bf16 v[12:15], v[176:179], v[108:111], v[12:15]
    v_mfma_f32_16x16x32_bf16 v[12:15], v[168:171], v[104:107], v[12:15]
    s_waitcnt lgkmcnt(3)
    v_mfma_f32_16x16x32_bf16 v[12:15], v[184:187], v[112:115], v[12:15]
    s_barrier
    ds_read_b64_tr_b16 v[164:165], v202 offset:24576
    v_mfma_f32_16x16x32_bf16 v[12:15], v[192:195], v[116:119], v[12:15]
    ds_read_b64_tr_b16 v[166:167], v202 offset:25088
    v_mfma_f32_16x16x32_bf16 v[20:23], v[184:187], v[116:119], v[20:23]
    ds_read_b64_tr_b16 v[172:173], v202 offset:28672
    v_mfma_f32_16x16x32_bf16 v[20:23], v[192:195], v[120:123], v[20:23]
    ds_read_b64_tr_b16 v[174:175], v202 offset:29184
    v_mfma_f32_16x16x32_bf16 v[28:31], v[184:187], v[120:123], v[28:31]
    ds_read_b64_tr_b16 v[168:169], v203 offset:24576
    v_mfma_f32_16x16x32_bf16 v[28:31], v[192:195], v[124:127], v[28:31]
    ds_read_b64_tr_b16 v[170:171], v203 offset:25088
    v_mfma_f32_16x16x32_bf16 v[36:39], v[184:187], v[124:127], v[36:39]
    ds_read_b64_tr_b16 v[176:177], v203 offset:28672
    v_mfma_f32_16x16x32_bf16 v[36:39], v[192:195], v[128:131], v[36:39]
    ds_read_b64_tr_b16 v[178:179], v203 offset:29184
    v_mfma_f32_16x16x32_bf16 v[32:35], v[188:191], v[128:131], v[32:35]
    ds_read_b128 v[100:103], v197 offset:65280
    v_mfma_f32_16x16x32_bf16 v[32:35], v[180:183], v[124:127], v[32:35]
    ds_read_b128 v[104:107], v199 offset:34816
    v_mfma_f32_16x16x32_bf16 v[24:27], v[188:191], v[124:127], v[24:27]
    v_mfma_f32_16x16x32_bf16 v[24:27], v[180:183], v[120:123], v[24:27]
    v_mfma_f32_16x16x32_bf16 v[16:19], v[188:191], v[120:123], v[16:19]
    v_mfma_f32_16x16x32_bf16 v[16:19], v[180:183], v[116:119], v[16:19]
    v_mfma_f32_16x16x32_bf16 v[8:11], v[188:191], v[116:119], v[8:11]
    v_mfma_f32_16x16x32_bf16 v[8:11], v[180:183], v[112:115], v[8:11]
    s_waitcnt lgkmcnt(2)
    v_mfma_f32_16x16x32_bf16 v[8:11], v[164:167], v[120:123], v[8:11]
    ds_read_b64_tr_b16 v[180:181], v202 offset:32768
    v_mfma_f32_16x16x32_bf16 v[8:11], v[172:175], v[124:127], v[8:11]
    ds_read_b64_tr_b16 v[182:183], v202 offset:33280
    v_mfma_f32_16x16x32_bf16 v[16:19], v[164:167], v[124:127], v[16:19]
    ds_read_b64_tr_b16 v[188:189], v202 offset:36864
    v_mfma_f32_16x16x32_bf16 v[16:19], v[172:175], v[128:131], v[16:19]
    ds_read_b64_tr_b16 v[190:191], v202 offset:37376
    v_mfma_f32_16x16x32_bf16 v[24:27], v[164:167], v[128:131], v[24:27]
    ds_read_b64_tr_b16 v[184:185], v203 offset:32768
    v_mfma_f32_16x16x32_bf16 v[24:27], v[172:175], v[132:135], v[24:27]
    ds_read_b64_tr_b16 v[186:187], v203 offset:33280
    v_mfma_f32_16x16x32_bf16 v[32:35], v[164:167], v[132:135], v[32:35]
    ds_read_b64_tr_b16 v[192:193], v203 offset:36864
    v_mfma_f32_16x16x32_bf16 v[32:35], v[172:175], v[136:139], v[32:35]
    ds_read_b64_tr_b16 v[194:195], v203 offset:37376
    v_mfma_f32_16x16x32_bf16 v[36:39], v[176:179], v[136:139], v[36:39]
    ds_read_b128 v[108:111], v199 offset:39168
    v_mfma_f32_16x16x32_bf16 v[36:39], v[168:171], v[132:135], v[36:39]
    ds_read_b128 v[112:115], v199 offset:43520
    v_mfma_f32_16x16x32_bf16 v[28:31], v[176:179], v[132:135], v[28:31]
    v_mfma_f32_16x16x32_bf16 v[28:31], v[168:171], v[128:131], v[28:31]
    v_mfma_f32_16x16x32_bf16 v[20:23], v[176:179], v[128:131], v[20:23]
    v_mfma_f32_16x16x32_bf16 v[20:23], v[168:171], v[124:127], v[20:23]
    v_mfma_f32_16x16x32_bf16 v[12:15], v[176:179], v[124:127], v[12:15]
    v_mfma_f32_16x16x32_bf16 v[12:15], v[168:171], v[120:123], v[12:15]
    s_waitcnt lgkmcnt(4)
    v_mfma_f32_16x16x32_bf16 v[32:35], v[180:183], v[140:143], v[32:35]
    ds_read_b64_tr_b16 v[164:165], v202 offset:40960
    v_mfma_f32_16x16x32_bf16 v[36:39], v[184:187], v[140:143], v[36:39]
    ds_read_b64_tr_b16 v[166:167], v202 offset:41472
    v_mfma_f32_16x16x32_bf16 v[28:31], v[184:187], v[136:139], v[28:31]
    ds_read_b64_tr_b16 v[168:169], v203 offset:40960
    v_mfma_f32_16x16x32_bf16 v[24:27], v[180:183], v[136:139], v[24:27]
    ds_read_b64_tr_b16 v[170:171], v203 offset:41472
    v_mfma_f32_16x16x32_bf16 v[16:19], v[180:183], v[132:135], v[16:19]
    ds_read_b128 v[116:119], v199 offset:47872
    v_mfma_f32_16x16x32_bf16 v[20:23], v[184:187], v[132:135], v[20:23]
    ds_read_b128 v[120:123], v199 offset:52224
    v_mfma_f32_16x16x32_bf16 v[12:15], v[184:187], v[128:131], v[12:15]
    v_mfma_f32_16x16x32_bf16 v[8:11], v[180:183], v[128:131], v[8:11]
    s_waitcnt lgkmcnt(2)
    v_mfma_f32_16x16x32_bf16 v[8:11], v[188:191], v[72:75], v[8:11]
    s_barrier
    ds_read_b64_tr_b16 v[172:173], v202 offset:45056
    v_mfma_f32_16x16x32_bf16 v[8:11], v[164:167], v[76:79], v[8:11]
    ds_read_b64_tr_b16 v[174:175], v202 offset:45568
    v_mfma_f32_16x16x32_bf16 v[16:19], v[188:191], v[76:79], v[16:19]
    ds_read_b64_tr_b16 v[180:181], v202 offset:49152
    v_mfma_f32_16x16x32_bf16 v[16:19], v[164:167], v[80:83], v[16:19]
    ds_read_b64_tr_b16 v[182:183], v202 offset:49664
    v_mfma_f32_16x16x32_bf16 v[24:27], v[188:191], v[80:83], v[24:27]
    ds_read_b64_tr_b16 v[176:177], v203 offset:45056
    v_mfma_f32_16x16x32_bf16 v[24:27], v[164:167], v[84:87], v[24:27]
    ds_read_b64_tr_b16 v[178:179], v203 offset:45568
    v_mfma_f32_16x16x32_bf16 v[32:35], v[188:191], v[84:87], v[32:35]
    ds_read_b64_tr_b16 v[184:185], v203 offset:49152
    v_mfma_f32_16x16x32_bf16 v[32:35], v[164:167], v[88:91], v[32:35]
    ds_read_b64_tr_b16 v[186:187], v203 offset:49664
    v_mfma_f32_16x16x32_bf16 v[36:39], v[168:171], v[88:91], v[36:39]
    ds_read_b128 v[124:127], v199 offset:56576
    v_mfma_f32_16x16x32_bf16 v[36:39], v[192:195], v[84:87], v[36:39]
    ds_read_b128 v[128:131], v199 offset:60928
    v_mfma_f32_16x16x32_bf16 v[28:31], v[168:171], v[84:87], v[28:31]
    v_mfma_f32_16x16x32_bf16 v[28:31], v[192:195], v[80:83], v[28:31]
    v_mfma_f32_16x16x32_bf16 v[20:23], v[168:171], v[80:83], v[20:23]
    v_mfma_f32_16x16x32_bf16 v[20:23], v[192:195], v[76:79], v[20:23]
    v_mfma_f32_16x16x32_bf16 v[12:15], v[168:171], v[76:79], v[12:15]
    v_mfma_f32_16x16x32_bf16 v[12:15], v[192:195], v[72:75], v[12:15]
    s_waitcnt lgkmcnt(2)
    v_mfma_f32_16x16x32_bf16 v[12:15], v[176:179], v[80:83], v[12:15]
    ds_read_b64_tr_b16 v[188:189], v202 offset:53248
    v_mfma_f32_16x16x32_bf16 v[12:15], v[184:187], v[84:87], v[12:15]
    ds_read_b64_tr_b16 v[190:191], v202 offset:53760
    v_mfma_f32_16x16x32_bf16 v[20:23], v[176:179], v[84:87], v[20:23]
    ds_read_b64_tr_b16 v[164:165], v202 offset:57344
    v_mfma_f32_16x16x32_bf16 v[20:23], v[184:187], v[88:91], v[20:23]
    ds_read_b64_tr_b16 v[166:167], v202 offset:57856
    v_mfma_f32_16x16x32_bf16 v[28:31], v[176:179], v[88:91], v[28:31]
    ds_read_b64_tr_b16 v[192:193], v203 offset:53248
    v_mfma_f32_16x16x32_bf16 v[28:31], v[184:187], v[92:95], v[28:31]
    ds_read_b64_tr_b16 v[194:195], v203 offset:53760
    v_mfma_f32_16x16x32_bf16 v[36:39], v[176:179], v[92:95], v[36:39]
    ds_read_b64_tr_b16 v[168:169], v203 offset:57344
    v_mfma_f32_16x16x32_bf16 v[36:39], v[184:187], v[96:99], v[36:39]
    ds_read_b64_tr_b16 v[170:171], v203 offset:57856
    v_mfma_f32_16x16x32_bf16 v[32:35], v[180:183], v[96:99], v[32:35]
    ds_read_b128 v[132:135], v199 offset:65280
    v_mfma_f32_16x16x32_bf16 v[32:35], v[172:175], v[92:95], v[32:35]
    ds_read_b128 v[136:139], v201 offset:34816
    v_mfma_f32_16x16x32_bf16 v[24:27], v[180:183], v[92:95], v[24:27]
    v_mfma_f32_16x16x32_bf16 v[24:27], v[172:175], v[88:91], v[24:27]
    v_mfma_f32_16x16x32_bf16 v[16:19], v[180:183], v[88:91], v[16:19]
    v_mfma_f32_16x16x32_bf16 v[16:19], v[172:175], v[84:87], v[16:19]
    v_mfma_f32_16x16x32_bf16 v[8:11], v[180:183], v[84:87], v[8:11]
    v_mfma_f32_16x16x32_bf16 v[8:11], v[172:175], v[80:83], v[8:11]
    s_waitcnt lgkmcnt(2)
    v_mfma_f32_16x16x32_bf16 v[8:11], v[188:191], v[88:91], v[8:11]
    ds_read_b64_tr_b16 v[172:173], v202 offset:61440
    v_mfma_f32_16x16x32_bf16 v[8:11], v[164:167], v[92:95], v[8:11]
    ds_read_b64_tr_b16 v[174:175], v202 offset:61952
    v_mfma_f32_16x16x32_bf16 v[16:19], v[188:191], v[92:95], v[16:19]
    ds_read_b64_tr_b16 v[180:181], v204 offset:24576
    v_mfma_f32_16x16x32_bf16 v[16:19], v[164:167], v[96:99], v[16:19]
    ds_read_b64_tr_b16 v[182:183], v204 offset:25088
    v_mfma_f32_16x16x32_bf16 v[24:27], v[188:191], v[96:99], v[24:27]
    ds_read_b64_tr_b16 v[176:177], v203 offset:61440
    v_mfma_f32_16x16x32_bf16 v[24:27], v[164:167], v[100:103], v[24:27]
    ds_read_b64_tr_b16 v[178:179], v203 offset:61952
    v_mfma_f32_16x16x32_bf16 v[32:35], v[188:191], v[100:103], v[32:35]
    ds_read_b64_tr_b16 v[184:185], v205 offset:24576
    v_mfma_f32_16x16x32_bf16 v[32:35], v[164:167], v[104:107], v[32:35]
    ds_read_b64_tr_b16 v[186:187], v205 offset:25088
    v_mfma_f32_16x16x32_bf16 v[36:39], v[168:171], v[104:107], v[36:39]
    ds_read_b128 v[140:143], v201 offset:39168
    v_mfma_f32_16x16x32_bf16 v[36:39], v[192:195], v[100:103], v[36:39]
    v_mfma_f32_16x16x32_bf16 v[28:31], v[168:171], v[100:103], v[28:31]
    v_mfma_f32_16x16x32_bf16 v[28:31], v[192:195], v[96:99], v[28:31]
    v_mfma_f32_16x16x32_bf16 v[20:23], v[168:171], v[96:99], v[20:23]
    v_mfma_f32_16x16x32_bf16 v[20:23], v[192:195], v[92:95], v[20:23]
    v_mfma_f32_16x16x32_bf16 v[12:15], v[168:171], v[92:95], v[12:15]
    v_mfma_f32_16x16x32_bf16 v[12:15], v[192:195], v[88:91], v[12:15]
    s_waitcnt lgkmcnt(1)
    v_mfma_f32_16x16x32_bf16 v[12:15], v[176:179], v[96:99], v[12:15]
    s_barrier
    ds_read_b64_tr_b16 v[188:189], v204 offset:28672
    v_mfma_f32_16x16x32_bf16 v[12:15], v[184:187], v[100:103], v[12:15]
    ds_read_b64_tr_b16 v[190:191], v204 offset:29184
    v_mfma_f32_16x16x32_bf16 v[20:23], v[176:179], v[100:103], v[20:23]
    ds_read_b64_tr_b16 v[164:165], v204 offset:32768
    v_mfma_f32_16x16x32_bf16 v[20:23], v[184:187], v[104:107], v[20:23]
    ds_read_b64_tr_b16 v[166:167], v204 offset:33280
    v_mfma_f32_16x16x32_bf16 v[28:31], v[176:179], v[104:107], v[28:31]
    ds_read_b64_tr_b16 v[192:193], v205 offset:28672
    v_mfma_f32_16x16x32_bf16 v[28:31], v[184:187], v[108:111], v[28:31]
    ds_read_b64_tr_b16 v[194:195], v205 offset:29184
    v_mfma_f32_16x16x32_bf16 v[36:39], v[176:179], v[108:111], v[36:39]
    ds_read_b64_tr_b16 v[168:169], v205 offset:32768
    v_mfma_f32_16x16x32_bf16 v[36:39], v[184:187], v[112:115], v[36:39]
    ds_read_b64_tr_b16 v[170:171], v205 offset:33280
    v_mfma_f32_16x16x32_bf16 v[32:35], v[180:183], v[112:115], v[32:35]
    ds_read_b128 v[88:91], v196 offset:52224
    v_mfma_f32_16x16x32_bf16 v[32:35], v[172:175], v[108:111], v[32:35]
    ds_read_b128 v[92:95], v196 offset:56576
    v_mfma_f32_16x16x32_bf16 v[24:27], v[180:183], v[108:111], v[24:27]
    v_mfma_f32_16x16x32_bf16 v[24:27], v[172:175], v[104:107], v[24:27]
    v_mfma_f32_16x16x32_bf16 v[16:19], v[180:183], v[104:107], v[16:19]
    v_mfma_f32_16x16x32_bf16 v[16:19], v[172:175], v[100:103], v[16:19]
    v_mfma_f32_16x16x32_bf16 v[8:11], v[180:183], v[100:103], v[8:11]
    v_mfma_f32_16x16x32_bf16 v[8:11], v[172:175], v[96:99], v[8:11]
    s_waitcnt lgkmcnt(2)
    v_mfma_f32_16x16x32_bf16 v[8:11], v[188:191], v[104:107], v[8:11]
    ds_read_b64_tr_b16 v[172:173], v204 offset:36864
    v_mfma_f32_16x16x32_bf16 v[8:11], v[164:167], v[108:111], v[8:11]
    ds_read_b64_tr_b16 v[174:175], v204 offset:37376
    v_mfma_f32_16x16x32_bf16 v[16:19], v[188:191], v[108:111], v[16:19]
    ds_read_b64_tr_b16 v[180:181], v204 offset:40960
    v_mfma_f32_16x16x32_bf16 v[16:19], v[164:167], v[112:115], v[16:19]
    ds_read_b64_tr_b16 v[182:183], v204 offset:41472
    v_mfma_f32_16x16x32_bf16 v[24:27], v[188:191], v[112:115], v[24:27]
    ds_read_b64_tr_b16 v[176:177], v205 offset:36864
    v_mfma_f32_16x16x32_bf16 v[24:27], v[164:167], v[116:119], v[24:27]
    ds_read_b64_tr_b16 v[178:179], v205 offset:37376
    v_mfma_f32_16x16x32_bf16 v[32:35], v[188:191], v[116:119], v[32:35]
    ds_read_b64_tr_b16 v[184:185], v205 offset:40960
    v_mfma_f32_16x16x32_bf16 v[32:35], v[164:167], v[120:123], v[32:35]
    ds_read_b64_tr_b16 v[186:187], v205 offset:41472
    v_mfma_f32_16x16x32_bf16 v[36:39], v[168:171], v[120:123], v[36:39]
    ds_read_b128 v[96:99], v196 offset:60928
    v_mfma_f32_16x16x32_bf16 v[36:39], v[192:195], v[116:119], v[36:39]
    ds_read_b128 v[100:103], v196 offset:65280
    v_mfma_f32_16x16x32_bf16 v[28:31], v[168:171], v[116:119], v[28:31]
    buffer_atomic_add v213, v212, s[36:39], 0 offen sc1
    v_mfma_f32_16x16x32_bf16 v[28:31], v[192:195], v[112:115], v[28:31]
    v_mfma_f32_16x16x32_bf16 v[20:23], v[168:171], v[112:115], v[20:23]
    v_mfma_f32_16x16x32_bf16 v[20:23], v[192:195], v[108:111], v[20:23]
    v_mfma_f32_16x16x32_bf16 v[12:15], v[168:171], v[108:111], v[12:15]
    v_mfma_f32_16x16x32_bf16 v[12:15], v[192:195], v[104:107], v[12:15]
    s_waitcnt lgkmcnt(2)
    v_mfma_f32_16x16x32_bf16 v[12:15], v[176:179], v[112:115], v[12:15]
    ds_read_b64_tr_b16 v[188:189], v204 offset:45056
    v_mfma_f32_16x16x32_bf16 v[12:15], v[184:187], v[116:119], v[12:15]
    ds_read_b64_tr_b16 v[190:191], v204 offset:45568
    v_mfma_f32_16x16x32_bf16 v[20:23], v[176:179], v[116:119], v[20:23]
    ds_read_b64_tr_b16 v[164:165], v204 offset:49152
    v_mfma_f32_16x16x32_bf16 v[20:23], v[184:187], v[120:123], v[20:23]
    ds_read_b64_tr_b16 v[166:167], v204 offset:49664
    v_mfma_f32_16x16x32_bf16 v[28:31], v[176:179], v[120:123], v[28:31]
    ds_read_b64_tr_b16 v[192:193], v205 offset:45056
    v_mfma_f32_16x16x32_bf16 v[28:31], v[184:187], v[124:127], v[28:31]
    ds_read_b64_tr_b16 v[194:195], v205 offset:45568
    v_mfma_f32_16x16x32_bf16 v[36:39], v[176:179], v[124:127], v[36:39]
    ds_read_b64_tr_b16 v[168:169], v205 offset:49152
    v_mfma_f32_16x16x32_bf16 v[36:39], v[184:187], v[128:131], v[36:39]
    ds_read_b64_tr_b16 v[170:171], v205 offset:49664
    v_mfma_f32_16x16x32_bf16 v[32:35], v[180:183], v[128:131], v[32:35]
    ds_read_b128 v[104:107], v198 offset:34816
    v_mfma_f32_16x16x32_bf16 v[32:35], v[172:175], v[124:127], v[32:35]
    ds_read_b128 v[108:111], v198 offset:39168
    v_mfma_f32_16x16x32_bf16 v[24:27], v[180:183], v[124:127], v[24:27]
    v_mfma_f32_16x16x32_bf16 v[24:27], v[172:175], v[120:123], v[24:27]
    v_mfma_f32_16x16x32_bf16 v[16:19], v[180:183], v[120:123], v[16:19]
    v_mfma_f32_16x16x32_bf16 v[16:19], v[172:175], v[116:119], v[16:19]
    v_mfma_f32_16x16x32_bf16 v[8:11], v[180:183], v[116:119], v[8:11]
    v_mfma_f32_16x16x32_bf16 v[8:11], v[172:175], v[112:115], v[8:11]
    s_waitcnt lgkmcnt(2)
    v_mfma_f32_16x16x32_bf16 v[8:11], v[188:191], v[120:123], v[8:11]
    ds_read_b64_tr_b16 v[172:173], v204 offset:53248
    v_mfma_f32_16x16x32_bf16 v[8:11], v[164:167], v[124:127], v[8:11]
    ds_read_b64_tr_b16 v[174:175], v204 offset:53760
    v_mfma_f32_16x16x32_bf16 v[16:19], v[188:191], v[124:127], v[16:19]
    ds_read_b64_tr_b16 v[180:181], v204 offset:0
    v_mfma_f32_16x16x32_bf16 v[16:19], v[164:167], v[128:131], v[16:19]
    ds_read_b64_tr_b16 v[182:183], v204 offset:512
    v_mfma_f32_16x16x32_bf16 v[24:27], v[188:191], v[128:131], v[24:27]
    ds_read_b64_tr_b16 v[176:177], v205 offset:53248
    v_mfma_f32_16x16x32_bf16 v[24:27], v[164:167], v[132:135], v[24:27]
    ds_read_b64_tr_b16 v[178:179], v205 offset:53760
    v_mfma_f32_16x16x32_bf16 v[32:35], v[188:191], v[132:135], v[32:35]
    ds_read_b64_tr_b16 v[184:185], v205 offset:0
    v_mfma_f32_16x16x32_bf16 v[32:35], v[164:167], v[136:139], v[32:35]
    ds_read_b64_tr_b16 v[186:187], v205 offset:512
    v_mfma_f32_16x16x32_bf16 v[36:39], v[168:171], v[136:139], v[36:39]
    ds_read_b128 v[112:115], v198 offset:43520
    v_mfma_f32_16x16x32_bf16 v[36:39], v[192:195], v[132:135], v[36:39]
    ds_read_b128 v[116:119], v198 offset:47872
    v_mfma_f32_16x16x32_bf16 v[28:31], v[168:171], v[132:135], v[28:31]
    v_and_b32 v4, 3, v1
    v_mfma_f32_16x16x32_bf16 v[28:31], v[192:195], v[128:131], v[28:31]
    s_lshl_b32 s49, s87, 3
    v_mfma_f32_16x16x32_bf16 v[20:23], v[168:171], v[128:131], v[20:23]
    v_lshl_add_u32 v4, v4, 1, s49
    v_mfma_f32_16x16x32_bf16 v[20:23], v[192:195], v[124:127], v[20:23]
    global_load_ushort v208, v4, s[8:9]
    v_mfma_f32_16x16x32_bf16 v[12:15], v[168:171], v[124:127], v[12:15]
    global_load_ushort v209, v4, s[10:11]
    v_mfma_f32_16x16x32_bf16 v[12:15], v[192:195], v[120:123], v[12:15]
    global_load_ushort v210, v4, s[12:13]
    s_waitcnt lgkmcnt(4)
    v_mfma_f32_16x16x32_bf16 v[32:35], v[172:175], v[140:143], v[32:35]
    ds_read_b64_tr_b16 v[188:189], v204 offset:4096
    v_mfma_f32_16x16x32_bf16 v[36:39], v[176:179], v[140:143], v[36:39]
    ds_read_b64_tr_b16 v[190:191], v204 offset:4608
    v_mfma_f32_16x16x32_bf16 v[28:31], v[176:179], v[136:139], v[28:31]
    ds_read_b64_tr_b16 v[192:193], v205 offset:4096
    v_mfma_f32_16x16x32_bf16 v[24:27], v[172:175], v[136:139], v[24:27]
    ds_read_b64_tr_b16 v[194:195], v205 offset:4608
    v_mfma_f32_16x16x32_bf16 v[16:19], v[172:175], v[132:135], v[16:19]
    ds_read_b128 v[120:123], v198 offset:52224
    v_mfma_f32_16x16x32_bf16 v[20:23], v[176:179], v[132:135], v[20:23]
    ds_read_b128 v[124:127], v198 offset:56576
    v_mfma_f32_16x16x32_bf16 v[12:15], v[176:179], v[128:131], v[12:15]
    v_mfma_f32_16x16x32_bf16 v[8:11], v[172:175], v[128:131], v[8:11]
    s_waitcnt lgkmcnt(2)
    v_mfma_f32_16x16x32_bf16 v[40:43], v[180:183], v[88:91], v[40:43]
    ds_read_b64_tr_b16 v[164:165], v204 offset:8192
    v_mfma_f32_16x16x32_bf16 v[40:43], v[188:191], v[92:95], v[40:43]
    ds_read_b64_tr_b16 v[166:167], v204 offset:8704
    v_mfma_f32_16x16x32_bf16 v[48:51], v[180:183], v[92:95], v[48:51]
    ds_read_b64_tr_b16 v[172:173], v204 offset:12288
    v_mfma_f32_16x16x32_bf16 v[48:51], v[188:191], v[96:99], v[48:51]
    ds_read_b64_tr_b16 v[174:175], v204 offset:12800
    v_mfma_f32_16x16x32_bf16 v[56:59], v[180:183], v[96:99], v[56:59]
    ds_read_b64_tr_b16 v[168:169], v205 offset:8192
    v_mfma_f32_16x16x32_bf16 v[56:59], v[188:191], v[100:103], v[56:59]
    ds_read_b64_tr_b16 v[170:171], v205 offset:8704
    v_mfma_f32_16x16x32_bf16 v[64:67], v[180:183], v[100:103], v[64:67]
    ds_read_b64_tr_b16 v[176:177], v205 offset:12288
    v_mfma_f32_16x16x32_bf16 v[64:67], v[188:191], v[104:107], v[64:67]
    ds_read_b64_tr_b16 v[178:179], v205 offset:12800
    v_mfma_f32_16x16x32_bf16 v[68:71], v[192:195], v[104:107], v[68:71]
    ds_read_b128 v[128:131], v198 offset:60928
    v_mfma_f32_16x16x32_bf16 v[68:71], v[184:187], v[100:103], v[68:71]
    ds_read_b128 v[132:135], v198 offset:65280
    v_mfma_f32_16x16x32_bf16 v[60:63], v[192:195], v[100:103], v[60:63]
    ds_read_b128 v[136:139], v200 offset:34816
    v_mfma_f32_16x16x32_bf16 v[60:63], v[184:187], v[96:99], v[60:63]
    ds_read_b128 v[140:143], v200 offset:39168
    v_mfma_f32_16x16x32_bf16 v[52:55], v[192:195], v[96:99], v[52:55]
    v_cvt_pk_bf16_f32 v8, v8, v9
    v_cvt_pk_bf16_f32 v9, v10, v11
    v_mfma_f32_16x16x32_bf16 v[52:55], v[184:187], v[92:95], v[52:55]
    v_cvt_pk_bf16_f32 v10, v16, v17
    v_cvt_pk_bf16_f32 v11, v18, v19
    v_mfma_f32_16x16x32_bf16 v[44:47], v[192:195], v[92:95], v[44:47]
    buffer_store_dwordx4 v[8:11], v206, s[28:31], s63 offen offset:0 sc1
    v_cvt_pk_bf16_f32 v12, v12, v13
    v_mfma_f32_16x16x32_bf16 v[44:47], v[184:187], v[88:91], v[44:47]
    v_cvt_pk_bf16_f32 v13, v14, v15
    v_cvt_pk_bf16_f32 v14, v20, v21
    s_waitcnt lgkmcnt(4)
    v_mfma_f32_16x16x32_bf16 v[44:47], v[168:171], v[96:99], v[44:47]
    ds_read_b64_tr_b16 v[180:181], v204 offset:16384
    v_mfma_f32_16x16x32_bf16 v[44:47], v[176:179], v[100:103], v[44:47]
    ds_read_b64_tr_b16 v[182:183], v204 offset:16896
    v_mfma_f32_16x16x32_bf16 v[52:55], v[168:171], v[100:103], v[52:55]
    ds_read_b64_tr_b16 v[188:189], v204 offset:20480
    v_mfma_f32_16x16x32_bf16 v[52:55], v[176:179], v[104:107], v[52:55]
    ds_read_b64_tr_b16 v[190:191], v204 offset:20992
    v_mfma_f32_16x16x32_bf16 v[60:63], v[168:171], v[104:107], v[60:63]
    ds_read_b64_tr_b16 v[184:185], v205 offset:16384
    v_mfma_f32_16x16x32_bf16 v[60:63], v[176:179], v[108:111], v[60:63]
    ds_read_b64_tr_b16 v[186:187], v205 offset:16896
    v_mfma_f32_16x16x32_bf16 v[68:71], v[168:171], v[108:111], v[68:71]
    ds_read_b64_tr_b16 v[192:193], v205 offset:20480
    v_mfma_f32_16x16x32_bf16 v[68:71], v[176:179], v[112:115], v[68:71]
    s_branch L_over2
L_pad2:
    s_branch L_hopped
L_over2:
    ds_read_b64_tr_b16 v[194:195], v205 offset:20992
    v_mfma_f32_16x16x32_bf16 v[64:67], v[172:175], v[112:115], v[64:67]
    ds_read_b128 v[144:147], v200 offset:43520
    v_mfma_f32_16x16x32_bf16 v[64:67], v[164:167], v[108:111], v[64:67]
    ds_read_b128 v[148:151], v200 offset:47872
    v_mfma_f32_16x16x32_bf16 v[56:59], v[172:175], v[108:111], v[56:59]
    ds_read_b128 v[152:155], v200 offset:52224
    v_mfma_f32_16x16x32_bf16 v[56:59], v[164:167], v[104:107], v[56:59]
    v_cvt_pk_bf16_f32 v15, v22, v23
    buffer_store_dwordx4 v[12:15], v206, s[28:31], s64 offen offset:0 sc1
    v_mfma_f32_16x16x32_bf16 v[48:51], v[172:175], v[104:107], v[48:51]
    v_cvt_pk_bf16_f32 v24, v24, v25
    v_cvt_pk_bf16_f32 v25, v26, v27
    v_mfma_f32_16x16x32_bf16 v[48:51], v[164:167], v[100:103], v[48:51]
    v_cvt_pk_bf16_f32 v26, v32, v33
    v_mfma_f32_16x16x32_bf16 v[40:43], v[172:175], v[100:103], v[40:43]
    v_cvt_pk_bf16_f32 v27, v34, v35
    buffer_store_dwordx4 v[24:27], v206, s[28:31], s63 offen offset:256 sc1
    v_mfma_f32_16x16x32_bf16 v[40:43], v[164:167], v[96:99], v[40:43]
    v_cvt_pk_bf16_f32 v28, v28, v29
    s_waitcnt lgkmcnt(3)
    v_mfma_f32_16x16x32_bf16 v[40:43], v[180:183], v[104:107], v[40:43]
    ds_read_b64_tr_b16 v[164:165], v202 offset:0
    v_mfma_f32_16x16x32_bf16 v[40:43], v[188:191], v[108:111], v[40:43]
    ds_read_b64_tr_b16 v[166:167], v202 offset:512
    v_mfma_f32_16x16x32_bf16 v[48:51], v[180:183], v[108:111], v[48:51]
    ds_read_b64_tr_b16 v[172:173], v202 offset:4096
    v_mfma_f32_16x16x32_bf16 v[48:51], v[188:191], v[112:115], v[48:51]
    ds_read_b64_tr_b16 v[174:175], v202 offset:4608
    v_mfma_f32_16x16x32_bf16 v[56:59], v[180:183], v[112:115], v[56:59]
    ds_read_b64_tr_b16 v[168:169], v203 offset:0
    v_mfma_f32_16x16x32_bf16 v[56:59], v[188:191], v[116:119], v[56:59]
    ds_read_b64_tr_b16 v[170:171], v203 offset:512
    v_mfma_f32_16x16x32_bf16 v[64:67], v[180:183], v[116:119], v[64:67]
    ds_read_b64_tr_b16 v[176:177], v203 offset:4096
    v_mfma_f32_16x16x32_bf16 v[64:67], v[188:191], v[120:123], v[64:67]
    ds_read_b64_tr_b16 v[178:179], v203 offset:4608
    v_mfma_f32_16x16x32_bf16 v[68:71], v[192:195], v[120:123], v[68:71]
    ds_read_b128 v[156:159], v200 offset:56576
    v_mfma_f32_16x16x32_bf16 v[68:71], v[184:187], v[116:119], v[68:71]
    v_cvt_pk_bf16_f32 v29, v30, v31
    v_mfma_f32_16x16x32_bf16 v[60:63], v[192:195], v[116:119], v[60:63]
    v_cvt_pk_bf16_f32 v30, v36, v37
    v_mfma_f32_16x16x32_bf16 v[60:63], v[184:187], v[112:115], v[60:63]
    v_mfma_f32_16x16x32_bf16 v[52:55], v[192:195], v[112:115], v[52:55]
    v_cvt_pk_bf16_f32 v31, v38, v39
    v_mfma_f32_16x16x32_bf16 v[52:55], v[184:187], v[108:111], v[52:55]
    v_mfma_f32_16x16x32_bf16 v[44:47], v[192:195], v[108:111], v[44:47]
    buffer_store_dwordx4 v[28:31], v206, s[28:31], s64 offen offset:256 sc1
    v_mfma_f32_16x16x32_bf16 v[44:47], v[184:187], v[104:107], v[44:47]
    s_waitcnt lgkmcnt(1)
    v_mfma_f32_16x16x32_bf16 v[44:47], v[168:171], v[112:115], v[44:47]
    ds_read_b64_tr_b16 v[180:181], v202 offset:8192
    v_mfma_f32_16x16x32_bf16 v[44:47], v[176:179], v[116:119], v[44:47]
    ds_read_b64_tr_b16 v[182:183], v202 offset:8704
    v_mfma_f32_16x16x32_bf16 v[52:55], v[168:171], v[116:119], v[52:55]
    ds_read_b64_tr_b16 v[188:189], v202 offset:12288
    v_mfma_f32_16x16x32_bf16 v[52:55], v[176:179], v[120:123], v[52:55]
    ds_read_b64_tr_b16 v[190:191], v202 offset:12800
    v_mfma_f32_16x16x32_bf16 v[60:63], v[168:171], v[120:123], v[60:63]
    ds_read_b64_tr_b16 v[184:185], v203 offset:8192
    v_mfma_f32_16x16x32_bf16 v[60:63], v[176:179], v[124:127], v[60:63]
    ds_read_b64_tr_b16 v[186:187], v203 offset:8704
    v_mfma_f32_16x16x32_bf16 v[68:71], v[168:171], v[124:127], v[68:71]
    ds_read_b64_tr_b16 v[192:193], v203 offset:12288
    v_mfma_f32_16x16x32_bf16 v[68:71], v[176:179], v[128:131], v[68:71]
    ds_read_b64_tr_b16 v[194:195], v203 offset:12800
    v_mfma_f32_16x16x32_bf16 v[64:67], v[172:175], v[128:131], v[64:67]
    ds_read_b128 v[88:91], v197 offset:52224
    v_mfma_f32_16x16x32_bf16 v[64:67], v[164:167], v[124:127], v[64:67]
    ds_read_b128 v[92:95], v197 offset:56576
    v_mfma_f32_16x16x32_bf16 v[56:59], v[172:175], v[124:127], v[56:59]
    ds_read_b128 v[96:99], v197 offset:60928
    v_mfma_f32_16x16x32_bf16 v[56:59], v[164:167], v[120:123], v[56:59]
    v_mfma_f32_16x16x32_bf16 v[48:51], v[172:175], v[120:123], v[48:51]
    v_mfma_f32_16x16x32_bf16 v[48:51], v[164:167], v[116:119], v[48:51]
    v_mfma_f32_16x16x32_bf16 v[40:43], v[172:175], v[116:119], v[40:43]
    v_mfma_f32_16x16x32_bf16 v[40:43], v[164:167], v[112:115], v[40:43]
    s_waitcnt lgkmcnt(3)
    v_mfma_f32_16x16x32_bf16 v[40:43], v[180:183], v[120:123], v[40:43]
    ds_read_b64_tr_b16 v[164:165], v202 offset:16384
    v_mfma_f32_16x16x32_bf16 v[40:43], v[188:191], v[124:127], v[40:43]
    ds_read_b64_tr_b16 v[166:167], v202 offset:16896
    v_mfma_f32_16x16x32_bf16 v[48:51], v[180:183], v[124:127], v[48:51]
    ds_read_b64_tr_b16 v[172:173], v202 offset:20480
    v_mfma_f32_16x16x32_bf16 v[48:51], v[188:191], v[128:131], v[48:51]
    ds_read_b64_tr_b16 v[174:175], v202 offset:20992
    v_mfma_f32_16x16x32_bf16 v[56:59], v[180:183], v[128:131], v[56:59]
    ds_read_b64_tr_b16 v[168:169], v203 offset:16384
    v_mfma_f32_16x16x32_bf16 v[56:59], v[188:191], v[132:135], v[56:59]
    ds_read_b64_tr_b16 v[170:171], v203 offset:16896
    v_mfma_f32_16x16x32_bf16 v[64:67], v[180:183], v[132:135], v[64:67]
    ds_read_b64_tr_b16 v[176:177], v203 offset:20480
    v_mfma_f32_16x16x32_bf16 v[64:67], v[188:191], v[136:139], v[64:67]
    ds_read_b64_tr_b16 v[178:179], v203 offset:20992
    v_mfma_f32_16x16x32_bf16 v[68:71], v[192:195], v[136:139], v[68:71]
    ds_read_b128 v[100:103], v197 offset:65280
    v_mfma_f32_16x16x32_bf16 v[68:71], v[184:187], v[132:135], v[68:71]
    ds_read_b128 v[104:107], v199 offset:34816
    v_mfma_f32_16x16x32_bf16 v[60:63], v[192:195], v[132:135], v[60:63]
    v_mfma_f32_16x16x32_bf16 v[60:63], v[184:187], v[128:131], v[60:63]
    v_mfma_f32_16x16x32_bf16 v[52:55], v[192:195], v[128:131], v[52:55]
    v_mfma_f32_16x16x32_bf16 v[52:55], v[184:187], v[124:127], v[52:55]
    v_mfma_f32_16x16x32_bf16 v[44:47], v[192:195], v[124:127], v[44:47]
    v_mfma_f32_16x16x32_bf16 v[44:47], v[184:187], v[120:123], v[44:47]
    s_waitcnt lgkmcnt(2)
    v_mfma_f32_16x16x32_bf16 v[44:47], v[168:171], v[128:131], v[44:47]
    ds_read_b64_tr_b16 v[180:181], v202 offset:24576
    v_mfma_f32_16x16x32_bf16 v[44:47], v[176:179], v[132:135], v[44:47]
    ds_read_b64_tr_b16 v[182:183], v202 offset:25088
    v_mfma_f32_16x16x32_bf16 v[52:55], v[168:171], v[132:135], v[52:55]
    ds_read_b64_tr_b16 v[188:189], v202 offset:28672
    v_mfma_f32_16x16x32_bf16 v[52:55], v[176:179], v[136:139], v[52:55]
    ds_read_b64_tr_b16 v[190:191], v202 offset:29184
    v_mfma_f32_16x16x32_bf16 v[60:63], v[168:171], v[136:139], v[60:63]
    ds_read_b64_tr_b16 v[184:185], v203 offset:24576
    v_mfma_f32_16x16x32_bf16 v[60:63], v[176:179], v[140:143], v[60:63]
    ds_read_b64_tr_b16 v[186:187], v203 offset:25088
    v_mfma_f32_16x16x32_bf16 v[68:71], v[168:171], v[140:143], v[68:71]
    ds_read_b64_tr_b16 v[192:193], v203 offset:28672
    v_mfma_f32_16x16x32_bf16 v[68:71], v[176:179], v[144:147], v[68:71]
    ds_read_b64_tr_b16 v[194:195], v203 offset:29184
    v_mfma_f32_16x16x32_bf16 v[64:67], v[172:175], v[144:147], v[64:67]
    ds_read_b128 v[108:111], v199 offset:39168
    v_mfma_f32_16x16x32_bf16 v[64:67], v[164:167], v[140:143], v[64:67]
    ds_read_b128 v[112:115], v199 offset:43520
    v_mfma_f32_16x16x32_bf16 v[56:59], v[172:175], v[140:143], v[56:59]
    v_mfma_f32_16x16x32_bf16 v[56:59], v[164:167], v[136:139], v[56:59]
    v_mfma_f32_16x16x32_bf16 v[48:51], v[172:175], v[136:139], v[48:51]
    v_mfma_f32_16x16x32_bf16 v[48:51], v[164:167], v[132:135], v[48:51]
    v_mfma_f32_16x16x32_bf16 v[40:43], v[172:175], v[132:135], v[40:43]
    v_mfma_f32_16x16x32_bf16 v[40:43], v[164:167], v[128:131], v[40:43]
    s_waitcnt lgkmcnt(2)
    v_mfma_f32_16x16x32_bf16 v[40:43], v[180:183], v[136:139], v[40:43]
    s_barrier
    ds_read_b64_tr_b16 v[164:165], v202 offset:32768
    v_mfma_f32_16x16x32_bf16 v[40:43], v[188:191], v[140:143], v[40:43]
    ds_read_b64_tr_b16 v[166:167], v202 offset:33280
    v_mfma_f32_16x16x32_bf16 v[48:51], v[180:183], v[140:143], v[48:51]
    ds_read_b64_tr_b16 v[172:173], v202 offset:36864
    v_mfma_f32_16x16x32_bf16 v[48:51], v[188:191], v[144:147], v[48:51]
    ds_read_b64_tr_b16 v[174:175], v202 offset:37376
    v_mfma_f32_16x16x32_bf16 v[56:59], v[180:183], v[144:147], v[56:59]
    ds_read_b64_tr_b16 v[168:169], v203 offset:32768
    v_mfma_f32_16x16x32_bf16 v[56:59], v[188:191], v[148:151], v[56:59]
    ds_read_b64_tr_b16 v[170:171], v203 offset:33280
    v_mfma_f32_16x16x32_bf16 v[64:67], v[180:183], v[148:151], v[64:67]
    ds_read_b64_tr_b16 v[176:177], v203 offset:36864
    v_mfma_f32_16x16x32_bf16 v[64:67], v[188:191], v[152:155], v[64:67]
    ds_read_b64_tr_b16 v[178:179], v203 offset:37376
    v_mfma_f32_16x16x32_bf16 v[68:71], v[192:195], v[152:155], v[68:71]
    ds_read_b128 v[116:119], v199 offset:47872
    v_mfma_f32_16x16x32_bf16 v[68:71], v[184:187], v[148:151], v[68:71]
    ds_read_b128 v[120:123], v199 offset:52224
    v_mfma_f32_16x16x32_bf16 v[60:63], v[192:195], v[148:151], v[60:63]
    v_mfma_f32_16x16x32_bf16 v[60:63], v[184:187], v[144:147], v[60:63]
    v_mfma_f32_16x16x32_bf16 v[52:55], v[192:195], v[144:147], v[52:55]
    v_mfma_f32_16x16x32_bf16 v[52:55], v[184:187], v[140:143], v[52:55]
    v_mfma_f32_16x16x32_bf16 v[44:47], v[192:195], v[140:143], v[44:47]
    v_mfma_f32_16x16x32_bf16 v[44:47], v[184:187], v[136:139], v[44:47]
    s_waitcnt lgkmcnt(4)
    v_mfma_f32_16x16x32_bf16 v[64:67], v[164:167], v[156:159], v[64:67]
    ds_read_b64_tr_b16 v[180:181], v202 offset:40960
    v_mfma_f32_16x16x32_bf16 v[68:71], v[168:171], v[156:159], v[68:71]
    ds_read_b64_tr_b16 v[182:183], v202 offset:41472
    v_mfma_f32_16x16x32_bf16 v[60:63], v[168:171], v[152:155], v[60:63]
    ds_read_b64_tr_b16 v[184:185], v203 offset:40960
    v_mfma_f32_16x16x32_bf16 v[56:59], v[164:167], v[152:155], v[56:59]
    ds_read_b64_tr_b16 v[186:187], v203 offset:41472
    v_mfma_f32_16x16x32_bf16 v[48:51], v[164:167], v[148:151], v[48:51]
    ds_read_b128 v[124:127], v199 offset:56576
    v_mfma_f32_16x16x32_bf16 v[52:55], v[168:171], v[148:151], v[52:55]
    ds_read_b128 v[128:131], v199 offset:60928
    v_mfma_f32_16x16x32_bf16 v[44:47], v[168:171], v[144:147], v[44:47]
    v_mfma_f32_16x16x32_bf16 v[40:43], v[164:167], v[144:147], v[40:43]
    s_waitcnt lgkmcnt(8)
    v_mfma_f32_16x16x32_bf16 v[40:43], v[172:175], v[88:91], v[40:43]
    ds_read_b64_tr_b16 v[188:189], v202 offset:45056
    v_mfma_f32_16x16x32_bf16 v[44:47], v[176:179], v[88:91], v[44:47]
    ds_read_b64_tr_b16 v[190:191], v202 offset:45568
    v_mfma_f32_16x16x32_bf16 v[52:55], v[176:179], v[92:95], v[52:55]
    ds_read_b64_tr_b16 v[192:193], v203 offset:45056
    v_mfma_f32_16x16x32_bf16 v[48:51], v[172:175], v[92:95], v[48:51]
    ds_read_b64_tr_b16 v[194:195], v203 offset:45568
    ds_read_b128 v[132:135], v199 offset:65280
    s_waitcnt lgkmcnt(7)
    v_mfma_f32_16x16x32_bf16 v[48:51], v[180:183], v[96:99], v[48:51]
    ds_read_b64_tr_b16 v[164:165], v202 offset:49152
    v_mfma_f32_16x16x32_bf16 v[52:55], v[184:187], v[96:99], v[52:55]
    ds_read_b64_tr_b16 v[166:167], v202 offset:49664
    v_mfma_f32_16x16x32_bf16 v[44:47], v[184:187], v[92:95], v[44:47]
    ds_read_b64_tr_b16 v[168:169], v203 offset:49152
    v_mfma_f32_16x16x32_bf16 v[40:43], v[180:183], v[92:95], v[40:43]
    ds_read_b64_tr_b16 v[170:171], v203 offset:49664
    ds_read_b128 v[136:139], v201 offset:34816
    s_waitcnt lgkmcnt(6)
    v_mfma_f32_16x16x32_bf16 v[40:43], v[188:191], v[96:99], v[40:43]
    ds_read_b64_tr_b16 v[172:173], v202 offset:53248
    v_mfma_f32_16x16x32_bf16 v[44:47], v[192:195], v[96:99], v[44:47]
    ds_read_b64_tr_b16 v[174:175], v202 offset:53760
    v_mfma_f32_16x16x32_bf16 v[52:55], v[192:195], v[100:103], v[52:55]
    ds_read_b64_tr_b16 v[176:177], v203 offset:53248
    v_mfma_f32_16x16x32_bf16 v[48:51], v[188:191], v[100:103], v[48:51]
    ds_read_b64_tr_b16 v[178:179], v203 offset:53760
    ds_read_b128 v[140:143], v201 offset:39168
    s_waitcnt lgkmcnt(6)
    v_mfma_f32_16x16x32_bf16 v[48:51], v[164:167], v[104:107], v[48:51]
    ds_read_b64_tr_b16 v[180:181], v202 offset:57344
    v_mfma_f32_16x16x32_bf16 v[52:55], v[168:171], v[104:107], v[52:55]
    ds_read_b64_tr_b16 v[182:183], v202 offset:57856
    v_mfma_f32_16x16x32_bf16 v[44:47], v[168:171], v[100:103], v[44:47]
    ds_read_b64_tr_b16 v[184:185], v203 offset:57344
    v_mfma_f32_16x16x32_bf16 v[40:43], v[164:167], v[100:103], v[40:43]
    ds_read_b64_tr_b16 v[186:187], v203 offset:57856
    ds_read_b128 v[144:147], v201 offset:43520
    s_waitcnt lgkmcnt(6)
    v_mfma_f32_16x16x32_bf16 v[40:43], v[172:175], v[104:107], v[40:43]
    ds_read_b64_tr_b16 v[188:189], v202 offset:61440
    v_mfma_f32_16x16x32_bf16 v[44:47], v[176:179], v[104:107], v[44:47]
    ds_read_b64_tr_b16 v[190:191], v202 offset:61952
    v_mfma_f32_16x16x32_bf16 v[52:55], v[176:179], v[108:111], v[52:55]
    ds_read_b64_tr_b16 v[192:193], v203 offset:61440
    v_mfma_f32_16x16x32_bf16 v[48:51], v[172:175], v[108:111], v[48:51]
    ds_read_b64_tr_b16 v[194:195], v203 offset:61952
    ds_read_b128 v[148:151], v201 offset:47872
    s_waitcnt lgkmcnt(6)
    v_mfma_f32_16x16x32_bf16 v[48:51], v[180:183], v[112:115], v[48:51]
    ds_read_b64_tr_b16 v[164:165], v204 offset:24576
    v_mfma_f32_16x16x32_bf16 v[52:55], v[184:187], v[112:115], v[52:55]
    ds_read_b64_tr_b16 v[166:167], v204 offset:25088
    v_mfma_f32_16x16x32_bf16 v[44:47], v[184:187], v[108:111], v[44:47]
    ds_read_b64_tr_b16 v[168:169], v205 offset:24576
    v_mfma_f32_16x16x32_bf16 v[40:43], v[180:183], v[108:111], v[40:43]
    ds_read_b64_tr_b16 v[170:171], v205 offset:25088
    s_waitcnt lgkmcnt(5)
    v_mfma_f32_16x16x32_bf16 v[40:43], v[188:191], v[112:115], v[40:43]
    ds_read_b64_tr_b16 v[172:173], v204 offset:28672
    v_mfma_f32_16x16x32_bf16 v[44:47], v[192:195], v[112:115], v[44:47]
    ds_read_b64_tr_b16 v[174:175], v204 offset:29184
    v_mfma_f32_16x16x32_bf16 v[52:55], v[192:195], v[116:119], v[52:55]
    ds_read_b64_tr_b16 v[176:177], v205 offset:28672
    v_mfma_f32_16x16x32_bf16 v[48:51], v[188:191], v[116:119], v[48:51]
    ds_read_b64_tr_b16 v[178:179], v205 offset:29184
    s_waitcnt lgkmcnt(4)
    v_mfma_f32_16x16x32_bf16 v[48:51], v[164:167], v[120:123], v[48:51]
    ds_read_b64_tr_b16 v[180:181], v204 offset:32768
    v_mfma_f32_16x16x32_bf16 v[52:55], v[168:171], v[120:123], v[52:55]
    ds_read_b64_tr_b16 v[182:183], v204 offset:33280
    v_mfma_f32_16x16x32_bf16 v[44:47], v[168:171], v[116:119], v[44:47]
    ds_read_b64_tr_b16 v[184:185], v205 offset:32768
    v_mfma_f32_16x16x32_bf16 v[40:43], v[164:167], v[116:119], v[40:43]
    ds_read_b64_tr_b16 v[186:187], v205 offset:33280
    s_waitcnt lgkmcnt(4)
    v_mfma_f32_16x16x32_bf16 v[40:43], v[172:175], v[120:123], v[40:43]
    ds_read_b64_tr_b16 v[188:189], v204 offset:36864
    v_mfma_f32_16x16x32_bf16 v[44:47], v[176:179], v[120:123], v[44:47]
    ds_read_b64_tr_b16 v[190:191], v204 offset:37376
    v_mfma_f32_16x16x32_bf16 v[52:55], v[176:179], v[124:127], v[52:55]
    ds_read_b64_tr_b16 v[192:193], v205 offset:36864
    v_mfma_f32_16x16x32_bf16 v[48:51], v[172:175], v[124:127], v[48:51]
    ds_read_b64_tr_b16 v[194:195], v205 offset:37376
    s_waitcnt lgkmcnt(4)
    v_mfma_f32_16x16x32_bf16 v[48:51], v[180:183], v[128:131], v[48:51]
    ds_read_b64_tr_b16 v[164:165], v204 offset:40960
    v_mfma_f32_16x16x32_bf16 v[52:55], v[184:187], v[128:131], v[52:55]
    ds_read_b64_tr_b16 v[166:167], v204 offset:41472
    v_mfma_f32_16x16x32_bf16 v[44:47], v[184:187], v[124:127], v[44:47]
    ds_read_b64_tr_b16 v[168:169], v205 offset:40960
    v_mfma_f32_16x16x32_bf16 v[40:43], v[180:183], v[124:127], v[40:43]
    ds_read_b64_tr_b16 v[170:171], v205 offset:41472
    s_waitcnt lgkmcnt(4)
    v_mfma_f32_16x16x32_bf16 v[40:43], v[188:191], v[128:131], v[40:43]
    ds_read_b64_tr_b16 v[172:173], v204 offset:45056
    v_mfma_f32_16x16x32_bf16 v[44:47], v[192:195], v[128:131], v[44:47]
    ds_read_b64_tr_b16 v[174:175], v204 offset:45568
    v_mfma_f32_16x16x32_bf16 v[52:55], v[192:195], v[132:135], v[52:55]
    ds_read_b64_tr_b16 v[176:177], v205 offset:45056
    v_mfma_f32_16x16x32_bf16 v[48:51], v[188:191], v[132:135], v[48:51]
    ds_read_b64_tr_b16 v[178:179], v205 offset:45568
    s_waitcnt lgkmcnt(4)
    v_mfma_f32_16x16x32_bf16 v[48:51], v[164:167], v[136:139], v[48:51]
    ds_read_b64_tr_b16 v[180:181], v204 offset:49152
    v_mfma_f32_16x16x32_bf16 v[52:55], v[168:171], v[136:139], v[52:55]
    ds_read_b64_tr_b16 v[182:183], v204 offset:49664
    v_mfma_f32_16x16x32_bf16 v[44:47], v[168:171], v[132:135], v[44:47]
    ds_read_b64_tr_b16 v[184:185], v205 offset:49152
    v_mfma_f32_16x16x32_bf16 v[40:43], v[164:167], v[132:135], v[40:43]
    ds_read_b64_tr_b16 v[186:187], v205 offset:49664
    s_waitcnt lgkmcnt(4)
    v_mfma_f32_16x16x32_bf16 v[40:43], v[172:175], v[136:139], v[40:43]
    ds_read_b64_tr_b16 v[188:189], v204 offset:53248
    v_mfma_f32_16x16x32_bf16 v[44:47], v[176:179], v[136:139], v[44:47]
    ds_read_b64_tr_b16 v[190:191], v204 offset:53760
    v_mfma_f32_16x16x32_bf16 v[52:55], v[176:179], v[140:143], v[52:55]
    ds_read_b64_tr_b16 v[192:193], v205 offset:53248
    v_mfma_f32_16x16x32_bf16 v[48:51], v[172:175], v[140:143], v[48:51]
    ds_read_b64_tr_b16 v[194:195], v205 offset:53760
    s_waitcnt lgkmcnt(4)
    v_mfma_f32_16x16x32_bf16 v[48:51], v[180:183], v[144:147], v[48:51]
    ds_read_b64_tr_b16 v[164:165], v202 offset:36864
    v_mfma_f32_16x16x32_bf16 v[52:55], v[184:187], v[144:147], v[52:55]
    ds_read_b64_tr_b16 v[166:167], v202 offset:37376
    v_mfma_f32_16x16x32_bf16 v[44:47], v[184:187], v[140:143], v[44:47]
    ds_read_b64_tr_b16 v[168:169], v203 offset:36864
    v_mfma_f32_16x16x32_bf16 v[40:43], v[180:183], v[140:143], v[40:43]
    ds_read_b64_tr_b16 v[170:171], v203 offset:37376
    s_waitcnt lgkmcnt(4)
    v_mfma_f32_16x16x32_bf16 v[40:43], v[188:191], v[144:147], v[40:43]
    ds_read_b64_tr_b16 v[172:173], v202 offset:40960
    v_mfma_f32_16x16x32_bf16 v[44:47], v[192:195], v[144:147], v[44:47]
    ds_read_b64_tr_b16 v[174:175], v202 offset:41472
    v_mfma_f32_16x16x32_bf16 v[52:55], v[192:195], v[148:151], v[52:55]
    ds_read_b64_tr_b16 v[176:177], v203 offset:40960
    v_mfma_f32_16x16x32_bf16 v[48:51], v[188:191], v[148:151], v[48:51]
    ds_read_b64_tr_b16 v[178:179], v203 offset:41472
    s_waitcnt lgkmcnt(4)
    v_mfma_f32_16x16x32_bf16 v[64:67], v[164:167], v[100:103], v[64:67]
    ds_read_b64_tr_b16 v[180:181], v202 offset:45056
    v_mfma_f32_16x16x32_bf16 v[68:71], v[168:171], v[100:103], v[68:71]
    ds_read_b64_tr_b16 v[182:183], v202 offset:45568
    v_mfma_f32_16x16x32_bf16 v[60:63], v[168:171], v[96:99], v[60:63]
    ds_read_b64_tr_b16 v[184:185], v203 offset:45056
    v_mfma_f32_16x16x32_bf16 v[56:59], v[164:167], v[96:99], v[56:59]
    ds_read_b64_tr_b16 v[186:187], v203 offset:45568
    v_cvt_pk_bf16_f32 v40, v40, v41
    v_cvt_pk_bf16_f32 v41, v42, v43
    v_cvt_pk_bf16_f32 v42, v48, v49
    v_cvt_pk_bf16_f32 v43, v50, v51
    s_waitcnt lgkmcnt(4)
    v_mfma_f32_16x16x32_bf16 v[56:59], v[172:175], v[100:103], v[56:59]
    ds_read_b64_tr_b16 v[188:189], v202 offset:49152
    v_mfma_f32_16x16x32_bf16 v[60:63], v[176:179], v[100:103], v[60:63]
    ds_read_b64_tr_b16 v[190:191], v202 offset:49664
    v_mfma_f32_16x16x32_bf16 v[68:71], v[176:179], v[104:107], v[68:71]
    ds_read_b64_tr_b16 v[192:193], v203 offset:49152
    v_mfma_f32_16x16x32_bf16 v[64:67], v[172:175], v[104:107], v[64:67]
    ds_read_b64_tr_b16 v[194:195], v203 offset:49664
    buffer_store_dwordx4 v[40:43], v206, s[28:31], s63 offen offset:2048 sc1
    v_cvt_pk_bf16_f32 v44, v44, v45
    v_cvt_pk_bf16_f32 v45, v46, v47
    v_cvt_pk_bf16_f32 v46, v52, v53
    s_waitcnt lgkmcnt(4)
    v_mfma_f32_16x16x32_bf16 v[64:67], v[180:183], v[108:111], v[64:67]
    ds_read_b64_tr_b16 v[164:165], v202 offset:53248
    v_mfma_f32_16x16x32_bf16 v[68:71], v[184:187], v[108:111], v[68:71]
    ds_read_b64_tr_b16 v[166:167], v202 offset:53760
    v_mfma_f32_16x16x32_bf16 v[60:63], v[184:187], v[104:107], v[60:63]
    ds_read_b64_tr_b16 v[168:169], v203 offset:53248
    v_mfma_f32_16x16x32_bf16 v[56:59], v[180:183], v[104:107], v[56:59]
    ds_read_b64_tr_b16 v[170:171], v203 offset:53760
    v_cvt_pk_bf16_f32 v47, v54, v55
    buffer_store_dwordx4 v[44:47], v206, s[28:31], s64 offen offset:2048 sc1
    s_waitcnt lgkmcnt(4)
    v_mfma_f32_16x16x32_bf16 v[56:59], v[188:191], v[108:111], v[56:59]
    ds_read_b64_tr_b16 v[172:173], v202 offset:57344
    v_mfma_f32_16x16x32_bf16 v[60:63], v[192:195], v[108:111], v[60:63]
    ds_read_b64_tr_b16 v[174:175], v202 offset:57856
    v_mfma_f32_16x16x32_bf16 v[68:71], v[192:195], v[112:115], v[68:71]
    ds_read_b64_tr_b16 v[176:177], v203 offset:57344
    v_mfma_f32_16x16x32_bf16 v[64:67], v[188:191], v[112:115], v[64:67]
    ds_read_b64_tr_b16 v[178:179], v203 offset:57856
    ds_read_b128 v[152:155], v201 offset:52224
    s_waitcnt lgkmcnt(5)
    v_mfma_f32_16x16x32_bf16 v[64:67], v[164:167], v[116:119], v[64:67]
    ds_read_b64_tr_b16 v[180:181], v202 offset:61440
    v_mfma_f32_16x16x32_bf16 v[68:71], v[168:171], v[116:119], v[68:71]
    ds_read_b64_tr_b16 v[182:183], v202 offset:61952
    v_mfma_f32_16x16x32_bf16 v[60:63], v[168:171], v[112:115], v[60:63]
    ds_read_b64_tr_b16 v[184:185], v203 offset:61440
    v_mfma_f32_16x16x32_bf16 v[56:59], v[164:167], v[112:115], v[56:59]
    ds_read_b64_tr_b16 v[186:187], v203 offset:61952
    ds_read_b128 v[156:159], v201 offset:56576
    s_waitcnt lgkmcnt(6)
    v_mfma_f32_16x16x32_bf16 v[56:59], v[172:175], v[116:119], v[56:59]
    ds_read_b64_tr_b16 v[188:189], v204 offset:24576
    v_mfma_f32_16x16x32_bf16 v[60:63], v[176:179], v[116:119], v[60:63]
    ds_read_b64_tr_b16 v[190:191], v204 offset:25088
    v_mfma_f32_16x16x32_bf16 v[68:71], v[176:179], v[120:123], v[68:71]
    ds_read_b64_tr_b16 v[192:193], v205 offset:24576
    v_mfma_f32_16x16x32_bf16 v[64:67], v[172:175], v[120:123], v[64:67]
    ds_read_b64_tr_b16 v[194:195], v205 offset:25088
    s_waitcnt lgkmcnt(5)
    v_mfma_f32_16x16x32_bf16 v[64:67], v[180:183], v[124:127], v[64:67]
    ds_read_b64_tr_b16 v[164:165], v204 offset:28672
    v_mfma_f32_16x16x32_bf16 v[68:71], v[184:187], v[124:127], v[68:71]
    ds_read_b64_tr_b16 v[166:167], v204 offset:29184
    v_mfma_f32_16x16x32_bf16 v[60:63], v[184:187], v[120:123], v[60:63]
    ds_read_b64_tr_b16 v[168:169], v205 offset:28672
    v_mfma_f32_16x16x32_bf16 v[56:59], v[180:183], v[120:123], v[56:59]
    ds_read_b64_tr_b16 v[170:171], v205 offset:29184
    s_waitcnt lgkmcnt(4)
    v_mfma_f32_16x16x32_bf16 v[56:59], v[188:191], v[124:127], v[56:59]
    ds_read_b64_tr_b16 v[172:173], v204 offset:32768
    v_mfma_f32_16x16x32_bf16 v[60:63], v[192:195], v[124:127], v[60:63]
    ds_read_b64_tr_b16 v[174:175], v204 offset:33280
    v_mfma_f32_16x16x32_bf16 v[68:71], v[192:195], v[128:131], v[68:71]
    ds_read_b64_tr_b16 v[176:177], v205 offset:32768
    v_mfma_f32_16x16x32_bf16 v[64:67], v[188:191], v[128:131], v[64:67]
    ds_read_b64_tr_b16 v[178:179], v205 offset:33280
    s_waitcnt lgkmcnt(4)
    v_mfma_f32_16x16x32_bf16 v[64:67], v[164:167], v[132:135], v[64:67]
    ds_read_b64_tr_b16 v[180:181], v204 offset:36864
    v_mfma_f32_16x16x32_bf16 v[68:71], v[168:171], v[132:135], v[68:71]
    ds_read_b64_tr_b16 v[182:183], v204 offset:37376
    v_mfma_f32_16x16x32_bf16 v[60:63], v[168:171], v[128:131], v[60:63]
    ds_read_b64_tr_b16 v[184:185], v205 offset:36864
    v_mfma_f32_16x16x32_bf16 v[56:59], v[164:167], v[128:131], v[56:59]
    ds_read_b64_tr_b16 v[186:187], v205 offset:37376
    s_waitcnt lgkmcnt(4)
    v_mfma_f32_16x16x32_bf16 v[56:59], v[172:175], v[132:135], v[56:59]
    ds_read_b64_tr_b16 v[188:189], v204 offset:40960
    v_mfma_f32_16x16x32_bf16 v[60:63], v[176:179], v[132:135], v[60:63]
    ds_read_b64_tr_b16 v[190:191], v204 offset:41472
    v_mfma_f32_16x16x32_bf16 v[68:71], v[176:179], v[136:139], v[68:71]
    ds_read_b64_tr_b16 v[192:193], v205 offset:40960
    v_mfma_f32_16x16x32_bf16 v[64:67], v[172:175], v[136:139], v[64:67]
    ds_read_b64_tr_b16 v[194:195], v205 offset:41472
    s_waitcnt lgkmcnt(4)
    v_mfma_f32_16x16x32_bf16 v[64:67], v[180:183], v[140:143], v[64:67]
    ds_read_b64_tr_b16 v[164:165], v204 offset:45056
    v_mfma_f32_16x16x32_bf16 v[68:71], v[184:187], v[140:143], v[68:71]
    ds_read_b64_tr_b16 v[166:167], v204 offset:45568
    v_mfma_f32_16x16x32_bf16 v[60:63], v[184:187], v[136:139], v[60:63]
    ds_read_b64_tr_b16 v[168:169], v205 offset:45056
    v_mfma_f32_16x16x32_bf16 v[56:59], v[180:183], v[136:139], v[56:59]
    ds_read_b64_tr_b16 v[170:171], v205 offset:45568
    s_waitcnt lgkmcnt(4)
    v_mfma_f32_16x16x32_bf16 v[56:59], v[188:191], v[140:143], v[56:59]
    ds_read_b64_tr_b16 v[172:173], v204 offset:49152
    v_mfma_f32_16x16x32_bf16 v[60:63], v[192:195], v[140:143], v[60:63]
    ds_read_b64_tr_b16 v[174:175], v204 offset:49664
    v_mfma_f32_16x16x32_bf16 v[68:71], v[192:195], v[144:147], v[68:71]
    ds_read_b64_tr_b16 v[176:177], v205 offset:49152
    v_mfma_f32_16x16x32_bf16 v[64:67], v[188:191], v[144:147], v[64:67]
    ds_read_b64_tr_b16 v[178:179], v205 offset:49664
    s_waitcnt lgkmcnt(4)
    v_mfma_f32_16x16x32_bf16 v[64:67], v[164:167], v[148:151], v[64:67]
    ds_read_b64_tr_b16 v[180:181], v204 offset:53248
    v_mfma_f32_16x16x32_bf16 v[68:71], v[168:171], v[148:151], v[68:71]
    ds_read_b64_tr_b16 v[182:183], v204 offset:53760
    v_mfma_f32_16x16x32_bf16 v[60:63], v[168:171], v[144:147], v[60:63]
    ds_read_b64_tr_b16 v[184:185], v205 offset:53248
    v_mfma_f32_16x16x32_bf16 v[56:59], v[164:167], v[144:147], v[56:59]
    ds_read_b64_tr_b16 v[186:187], v205 offset:53760
    s_waitcnt lgkmcnt(4)
    v_mfma_f32_16x16x32_bf16 v[56:59], v[172:175], v[148:151], v[56:59]
    v_mfma_f32_16x16x32_bf16 v[60:63], v[176:179], v[148:151], v[60:63]
    v_mfma_f32_16x16x32_bf16 v[68:71], v[176:179], v[152:155], v[68:71]
    v_mfma_f32_16x16x32_bf16 v[64:67], v[172:175], v[152:155], v[64:67]
    s_waitcnt lgkmcnt(0)
    v_mfma_f32_16x16x32_bf16 v[64:67], v[180:183], v[156:159], v[64:67]
    v_mfma_f32_16x16x32_bf16 v[68:71], v[184:187], v[156:159], v[68:71]
    v_mfma_f32_16x16x32_bf16 v[60:63], v[184:187], v[152:155], v[60:63]
    v_mfma_f32_16x16x32_bf16 v[56:59], v[180:183], v[152:155], v[56:59]
    s_nop 7
    v_cvt_pk_bf16_f32 v56, v56, v57
    v_cvt_pk_bf16_f32 v57, v58, v59
    v_cvt_pk_bf16_f32 v58, v64, v65
    v_cvt_pk_bf16_f32 v59, v66, v67
    buffer_store_dwordx4 v[56:59], v206, s[28:31], s63 offen offset:2304 sc1
    v_cvt_pk_bf16_f32 v60, v60, v61
    v_cvt_pk_bf16_f32 v61, v62, v63
    v_cvt_pk_bf16_f32 v62, v68, v69
    v_cvt_pk_bf16_f32 v63, v70, v71
    buffer_store_dwordx4 v[60:63], v206, s[28:31], s64 offen offset:2304 sc1
    s_barrier
    s_waitcnt vmcnt(8)
L_reduce:
    v_and_b32 v104, 0xff, v0
    v_bfe_u32 v72, v104, 6, 2
    v_lshlrev_b32 v72, 7, v72
    v_bfe_u32 v105, v104, 1, 4
    v_lshl_add_u32 v72, v105, 3, v72
    v_bfe_u32 v105, v104, 5, 1
    v_lshl_add_u32 v72, v105, 1, v72
    v_and_b32 v105, 1, v104
    v_add_u32 v72, v72, v105
    s_movk_i32 s92, 485
    v_cmp_gt_u32 s[90:91], s92, v72
    s_and_b32 s48, s45, 4
    v_add_u32 v72, s48, v72
    v_cmp_gt_u32 s[88:89], s92, v72
    v_lshlrev_b32 v72, 10, v72
    v_lshlrev_b32 v73, 4, v104
    v_lshlrev_b32 v87, 16, v208
    v_lshlrev_b32 v88, 16, v209
    v_lshlrev_b32 v89, 16, v210
    s_mov_b64 s[32:33], s[14:15]
    s_mov_b32 s34, 993280
    s_mov_b32 s35, 0x20000
    v_and_b32 v105, 3, v1
    v_lshlrev_b32 v91, 4, v105
    v_add_u32 v91, 159744, v91
    s_mov_b32 s17, 0x3b072033
    v_mov_b32 v82, 0xbdd2d3e8
    v_mov_b32 v83, 0xbdd2d3e8
    v_mov_b32 v84, 0xc0135761
    v_mov_b32 v85, 0xc0135761
    v_mov_b32 v86, 0x3727c5ac
    s_mul_i32 s18, s44, 496640
    s_lshl3_add_u32 s18, s87, s18
    s_cmp_lt_u32 s45, 4
    s_cbranch_scc0 L_gather
    s_barrier
    ds_read_b128 v[92:95], v73 offset:0
    s_branch L_final
L_gather:
    s_lshl_b32 s86, s44, 7
    s_add_u32 s86, s86, s87
    s_lshl_b32 s86, s86, 15
    s_add_u32 s59, s86, 4096
    v_and_b32 v220, 0xff, v0
    v_lshlrev_b32 v220, 3, v220
    v_add_u32 v221, 0x2000, v220
    v_add_u32 v222, 0x4000, v220
    v_add_u32 v223, 0x6000, v220
    s_lshr_b32 s48, s86, 19
    s_lshl_b32 s48, s48, 4
    v_mov_b32 v41, s48
    v_mov_b32_dpp v100, v87 quad_perm:[0,0,0,0] row_mask:0xf bank_mask:0xf
    v_mov_b32_dpp v101, v87 quad_perm:[1,1,1,1] row_mask:0xf bank_mask:0xf
    v_mov_b32_dpp v102, v87 quad_perm:[2,2,2,2] row_mask:0xf bank_mask:0xf
    v_mov_b32_dpp v103, v87 quad_perm:[3,3,3,3] row_mask:0xf bank_mask:0xf
    v_bfe_u32 v105, v1, 4, 1
    v_bfe_u32 v106, v1, 5, 1
    v_lshlrev_b32 v105, 4, v105
    v_lshl_add_u32 v105, v106, 6, v105
    s_lshl2_add_u32 s16, s58, 159744
    v_add_u32 v90, s16, v105
    s_mov_b32 s93, 0xffff0000
    s_barrier
    s_mov_b32 s49, 0
    s_mov_b64 exec, 1
L_chk:
    buffer_load_dword v15, v41, s[36:39], 0 offen sc1
    s_add_u32 s49, s49, 1
    s_waitcnt vmcnt(0)
    v_readfirstlane_b32 s48, v15
    s_cmp_gt_u32 s49, 0x40000
    s_cbranch_scc1 L_chk_end
    s_cmp_lt_u32 s48, 16
    s_cbranch_scc1 L_chk
L_chk_end:
    s_mov_b64 exec, -1
    buffer_load_dwordx2 v[128:129], v220, s[28:31], s86 offen offset:0 sc1
    buffer_load_dwordx2 v[130:131], v220, s[28:31], s59 offen offset:0 sc1
    buffer_load_dwordx2 v[132:133], v221, s[28:31], s86 offen offset:0 sc1
    buffer_load_dwordx2 v[134:135], v221, s[28:31], s59 offen offset:0 sc1
    buffer_load_dwordx2 v[136:137], v222, s[28:31], s86 offen offset:0 sc1
    buffer_load_dwordx2 v[138:139], v222, s[28:31], s59 offen offset:0 sc1
    buffer_load_dwordx2 v[140:141], v223, s[28:31], s86 offen offset:0 sc1
    buffer_load_dwordx2 v[142:143], v223, s[28:31], s59 offen offset:0 sc1
    s_barrier
    s_mov_b32 s48, 0
L_waita:
    s_waitcnt vmcnt(0)
    v_max_u32 v120, v128, v129
    v_max_u32 v121, v130, v131
    v_max_u32 v122, v132, v133
    v_max_u32 v123, v134, v135
    v_max_u32 v124, v136, v137
    v_max_u32 v125, v138, v139
    v_max_u32 v126, v140, v141
    v_max_u32 v127, v142, v143
    v_max3_u32 v104, v120, v121, v122
    v_max3_u32 v105, v123, v124, v125
    v_max3_u32 v104, v104, v126, v127
    v_max_u32 v104, v104, v105
    v_cmp_eq_u32 vcc, -1, v104
    s_add_u32 s48, s48, 1
    s_cmp_gt_u32 s48, 0x40000
    s_cbranch_scc1 L_gota
    s_nop 2
    s_cbranch_vccz L_gota
    v_cmp_eq_u32 vcc, -1, v120
    s_nop 4
    s_cbranch_vccz L_skipa0
    s_mov_b64 exec, vcc
    buffer_load_dwordx2 v[128:129], v220, s[28:31], s86 offen offset:0 sc1
    s_mov_b64 exec, -1
L_skipa0:
    v_cmp_eq_u32 vcc, -1, v121
    s_nop 4
    s_cbranch_vccz L_skipa1
    s_mov_b64 exec, vcc
    buffer_load_dwordx2 v[130:131], v220, s[28:31], s59 offen offset:0 sc1
    s_mov_b64 exec, -1
L_skipa1:
    v_cmp_eq_u32 vcc, -1, v122
    s_nop 4
    s_cbranch_vccz L_skipa2
    s_mov_b64 exec, vcc
    buffer_load_dwordx2 v[132:133], v221, s[28:31], s86 offen offset:0 sc1
    s_mov_b64 exec, -1
L_skipa2:
    v_cmp_eq_u32 vcc, -1, v123
    s_nop 4
    s_cbranch_vccz L_skipa3
    s_mov_b64 exec, vcc
    buffer_load_dwordx2 v[134:135], v221, s[28:31], s59 offen offset:0 sc1
    s_mov_b64 exec, -1
L_skipa3:
    v_cmp_eq_u32 vcc, -1, v124
    s_nop 4
    s_cbranch_vccz L_skipa4
    s_mov_b64 exec, vcc
    buffer_load_dwordx2 v[136:137], v222, s[28:31], s86 offen offset:0 sc1
    s_mov_b64 exec, -1
L_skipa4:
    v_cmp_eq_u32 vcc, -1, v125
    s_nop 4
    s_cbranch_vccz L_skipa5
    s_mov_b64 exec, vcc
    buffer_load_dwordx2 v[138:139], v222, s[28:31], s59 offen offset:0 sc1
    s_mov_b64 exec, -1
L_skipa5:
    v_cmp_eq_u32 vcc, -1, v126
    s_nop 4
    s_cbranch_vccz L_skipa6
    s_mov_b64 exec, vcc
    buffer_load_dwordx2 v[140:141], v223, s[28:31], s86 offen offset:0 sc1
    s_mov_b64 exec, -1
L_skipa6:
    v_cmp_eq_u32 vcc, -1, v127
    s_nop 4
    s_cbranch_vccz L_skipa7
    s_mov_b64 exec, vcc
    buffer_load_dwordx2 v[142:143], v223, s[28:31], s59 offen offset:0 sc1
    s_mov_b64 exec, -1
L_skipa7:
    s_branch L_waita
L_gota:
    s_mov_b32 exec_hi, 0
    buffer_load_dwordx2 v[144:145], v220, s[28:31], s86 offen offset:2048 sc1
    buffer_load_dwordx2 v[146:147], v220, s[28:31], s59 offen offset:2048 sc1
    buffer_load_dwordx2 v[148:149], v221, s[28:31], s86 offen offset:2048 sc1
    buffer_load_dwordx2 v[150:151], v221, s[28:31], s59 offen offset:2048 sc1
    buffer_load_dwordx2 v[152:153], v222, s[28:31], s86 offen offset:2048 sc1
    buffer_load_dwordx2 v[154:155], v222, s[28:31], s59 offen offset:2048 sc1
    buffer_load_dwordx2 v[156:157], v223, s[28:31], s86 offen offset:2048 sc1
    buffer_load_dwordx2 v[158:159], v223, s[28:31], s59 offen offset:2048 sc1
    s_mov_b32 exec_hi, -1
    v_lshlrev_b32 v160, 16, v128
    v_and_b32 v161, s93, v128
    v_lshlrev_b32 v162, 16, v129
    v_and_b32 v163, s93, v129
    v_lshlrev_b32 v164, 16, v130
    v_and_b32 v165, s93, v130
    v_lshlrev_b32 v166, 16, v131
    v_and_b32 v167, s93, v131
    v_pk_add_f32 v[160:161], v[160:161], v[164:165]
    v_pk_add_f32 v[162:163], v[162:163], v[166:167]
    v_lshlrev_b32 v168, 16, v132
    v_and_b32 v169, s93, v132
    v_lshlrev_b32 v170, 16, v133
    v_and_b32 v171, s93, v133
    v_lshlrev_b32 v172, 16, v134
    v_and_b32 v173, s93, v134
    v_lshlrev_b32 v174, 16, v135
    v_and_b32 v175, s93, v135
    v_pk_add_f32 v[168:169], v[168:169], v[172:173]
    v_pk_add_f32 v[170:171], v[170:171], v[174:175]
    v_lshlrev_b32 v176, 16, v136
    v_and_b32 v177, s93, v136
    v_lshlrev_b32 v178, 16, v137
    v_and_b32 v179, s93, v137
    v_lshlrev_b32 v180, 16, v138
    v_and_b32 v181, s93, v138
    v_lshlrev_b32 v182, 16, v139
    v_and_b32 v183, s93, v139
    v_pk_add_f32 v[176:177], v[176:177], v[180:181]
    v_pk_add_f32 v[178:179], v[178:179], v[182:183]
    v_lshlrev_b32 v184, 16, v140
    v_and_b32 v185, s93, v140
    v_lshlrev_b32 v186, 16, v141
    v_and_b32 v187, s93, v141
    v_lshlrev_b32 v188, 16, v142
    v_and_b32 v189, s93, v142
    v_lshlrev_b32 v190, 16, v143
    v_and_b32 v191, s93, v143
    v_pk_add_f32 v[184:185], v[184:185], v[188:189]
    v_pk_add_f32 v[186:187], v[186:187], v[190:191]
    v_pk_add_f32 v[160:161], v[160:161], v[168:169]
    v_pk_add_f32 v[162:163], v[162:163], v[170:171]
    v_pk_add_f32 v[176:177], v[176:177], v[184:185]
    v_pk_add_f32 v[178:179], v[178:179], v[186:187]
    v_pk_add_f32 v[96:97], v[160:161], v[176:177]
    v_pk_add_f32 v[98:99], v[162:163], v[178:179]
    v_cndmask_b32 v74, 0, v96, s[90:91]
    v_cndmask_b32 v75, 0, v97, s[90:91]
    v_cndmask_b32 v76, 0, v98, s[90:91]
    v_cndmask_b32 v77, 0, v99, s[90:91]
    v_pk_mul_f32 v[78:79], v[74:75], v[74:75]
    v_pk_mul_f32 v[80:81], v[76:77], v[76:77]
    v_pk_add_f32 v[96:97], v[96:97], v[100:101]
    v_pk_add_f32 v[98:99], v[98:99], v[102:103]
    ds_write_b128 v73, v[96:99] offset:0
    s_mov_b32 exec_lo, 0
    buffer_load_dwordx2 v[144:145], v220, s[28:31], s86 offen offset:2048 sc1
    buffer_load_dwordx2 v[146:147], v220, s[28:31], s59 offen offset:2048 sc1
    buffer_load_dwordx2 v[148:149], v221, s[28:31], s86 offen offset:2048 sc1
    buffer_load_dwordx2 v[150:151], v221, s[28:31], s59 offen offset:2048 sc1
    buffer_load_dwordx2 v[152:153], v222, s[28:31], s86 offen offset:2048 sc1
    buffer_load_dwordx2 v[154:155], v222, s[28:31], s59 offen offset:2048 sc1
    buffer_load_dwordx2 v[156:157], v223, s[28:31], s86 offen offset:2048 sc1
    buffer_load_dwordx2 v[158:159], v223, s[28:31], s59 offen offset:2048 sc1
    s_mov_b32 exec_lo, -1
    s_mov_b32 s48, 0
L_waitb:
    s_waitcnt vmcnt(0)
    v_max_u32 v120, v144, v145
    v_max_u32 v121, v146, v147
    v_max_u32 v122, v148, v149
    v_max_u32 v123, v150, v151
    v_max_u32 v124, v152, v153
    v_max_u32 v125, v154, v155
    v_max_u32 v126, v156, v157
    v_max_u32 v127, v158, v159
    v_max3_u32 v104, v120, v121, v122
    v_max3_u32 v105, v123, v124, v125
    v_max3_u32 v104, v104, v126, v127
    v_max_u32 v104, v104, v105
    v_cmp_eq_u32 vcc, -1, v104
    s_add_u32 s48, s48, 1
    s_cmp_gt_u32 s48, 0x40000
    s_cbranch_scc1 L_gotb
    s_nop 2
    s_cbranch_vccz L_gotb
    v_cmp_eq_u32 vcc, -1, v120
    s_nop 4
    s_cbranch_vccz L_skipb0
    s_mov_b64 exec, vcc
    buffer_load_dwordx2 v[144:145], v220, s[28:31], s86 offen offset:2048 sc1
    s_mov_b64 exec, -1
L_skipb0:
    v_cmp_eq_u32 vcc, -1, v121
    s_nop 4
    s_cbranch_vccz L_skipb1
    s_mov_b64 exec, vcc
    buffer_load_dwordx2 v[146:147], v220, s[28:31], s59 offen offset:2048 sc1
    s_mov_b64 exec, -1
L_skipb1:
    v_cmp_eq_u32 vcc, -1, v122
    s_nop 4
    s_cbranch_vccz L_skipb2
    s_mov_b64 exec, vcc
    buffer_load_dwordx2 v[148:149], v221, s[28:31], s86 offen offset:2048 sc1
    s_mov_b64 exec, -1
L_skipb2:
    v_cmp_eq_u32 vcc, -1, v123
    s_nop 4
    s_cbranch_vccz L_skipb3
    s_mov_b64 exec, vcc
    buffer_load_dwordx2 v[150:151], v221, s[28:31], s59 offen offset:2048 sc1
    s_mov_b64 exec, -1
L_skipb3:
    v_cmp_eq_u32 vcc, -1, v124
    s_nop 4
    s_cbranch_vccz L_skipb4
    s_mov_b64 exec, vcc
    buffer_load_dwordx2 v[152:153], v222, s[28:31], s86 offen offset:2048 sc1
    s_mov_b64 exec, -1
L_skipb4:
    v_cmp_eq_u32 vcc, -1, v125
    s_nop 4
    s_cbranch_vccz L_skipb5
    s_mov_b64 exec, vcc
    buffer_load_dwordx2 v[154:155], v222, s[28:31], s59 offen offset:2048 sc1
    s_mov_b64 exec, -1
L_skipb5:
    v_cmp_eq_u32 vcc, -1, v126
    s_nop 4
    s_cbranch_vccz L_skipb6
    s_mov_b64 exec, vcc
    buffer_load_dwordx2 v[156:157], v223, s[28:31], s86 offen offset:2048 sc1
    s_mov_b64 exec, -1
L_skipb6:
    v_cmp_eq_u32 vcc, -1, v127
    s_nop 4
    s_cbranch_vccz L_skipb7
    s_mov_b64 exec, vcc
    buffer_load_dwordx2 v[158:159], v223, s[28:31], s59 offen offset:2048 sc1
    s_mov_b64 exec, -1
L_skipb7:
    s_branch L_waitb
L_gotb:
    v_lshlrev_b32 v160, 16, v144
    v_and_b32 v161, s93, v144
    v_lshlrev_b32 v162, 16, v145
    v_and_b32 v163, s93, v145
    v_lshlrev_b32 v164, 16, v146
    v_and_b32 v165, s93, v146
    v_lshlrev_b32 v166, 16, v147
    v_and_b32 v167, s93, v147
    v_pk_add_f32 v[160:161], v[160:161], v[164:165]
    v_pk_add_f32 v[162:163], v[162:163], v[166:167]
    v_lshlrev_b32 v168, 16, v148
    v_and_b32 v169, s93, v148
    v_lshlrev_b32 v170, 16, v149
    v_and_b32 v171, s93, v149
    v_lshlrev_b32 v172, 16, v150
    v_and_b32 v173, s93, v150
    v_lshlrev_b32 v174, 16, v151
    v_and_b32 v175, s93, v151
    v_pk_add_f32 v[168:169], v[168:169], v[172:173]
    v_pk_add_f32 v[170:171], v[170:171], v[174:175]
    v_lshlrev_b32 v176, 16, v152
    v_and_b32 v177, s93, v152
    v_lshlrev_b32 v178, 16, v153
    v_and_b32 v179, s93, v153
    v_lshlrev_b32 v180, 16, v154
    v_and_b32 v181, s93, v154
    v_lshlrev_b32 v182, 16, v155
    v_and_b32 v183, s93, v155
    v_pk_add_f32 v[176:177], v[176:177], v[180:181]
    v_pk_add_f32 v[178:179], v[178:179], v[182:183]
    v_lshlrev_b32 v184, 16, v156
    v_and_b32 v185, s93, v156
    v_lshlrev_b32 v186, 16, v157
    v_and_b32 v187, s93, v157
    v_lshlrev_b32 v188, 16, v158
    v_and_b32 v189, s93, v158
    v_lshlrev_b32 v190, 16, v159
    v_and_b32 v191, s93, v159
    v_pk_add_f32 v[184:185], v[184:185], v[188:189]
    v_pk_add_f32 v[186:187], v[186:187], v[190:191]
    v_pk_add_f32 v[160:161], v[160:161], v[168:169]
    v_pk_add_f32 v[162:163], v[162:163], v[170:171]
    v_pk_add_f32 v[176:177], v[176:177], v[184:185]
    v_pk_add_f32 v[178:179], v[178:179], v[186:187]
    v_pk_add_f32 v[92:93], v[160:161], v[176:177]
    v_pk_add_f32 v[94:95], v[162:163], v[178:179]
    v_cndmask_b32 v104, 0, v92, s[88:89]
    v_cndmask_b32 v105, 0, v93, s[88:89]
    v_cndmask_b32 v106, 0, v94, s[88:89]
    v_cndmask_b32 v107, 0, v95, s[88:89]
    v_pk_fma_f32 v[112:113], v[104:105], v[104:105], v[78:79]
    v_pk_fma_f32 v[114:115], v[106:107], v[106:107], v[80:81]
    v_pk_add_f32 v[108:109], v[104:105], v[74:75]
    v_pk_add_f32 v[110:111], v[106:107], v[76:77]
    v_pk_add_f32 v[92:93], v[92:93], v[100:101]
    v_pk_add_f32 v[94:95], v[94:95], v[102:103]
    v_permlane32_swap_b32 v108, v112
    v_permlane32_swap_b32 v109, v113
    v_permlane32_swap_b32 v110, v114
    v_permlane32_swap_b32 v111, v115
    s_nop 0
    v_pk_add_f32 v[108:109], v[108:109], v[112:113]
    v_pk_add_f32 v[110:111], v[110:111], v[114:115]
    s_nop 0
    v_permlane16_swap_b32 v108, v109
    v_permlane16_swap_b32 v110, v111
    s_nop 0
    v_add_f32 v108, v108, v109
    v_add_f32 v110, v110, v111
    s_nop 0
    v_add_f32_dpp v108, v108, v108 row_ror:8 row_mask:0xf bank_mask:0xf
    v_add_f32_dpp v110, v110, v110 row_ror:8 row_mask:0xf bank_mask:0xf
    s_nop 0
    v_add_f32_dpp v108, v108, v108 row_ror:4 row_mask:0xf bank_mask:0xf
    v_add_f32_dpp v110, v110, v110 row_ror:4 row_mask:0xf bank_mask:0xf
    s_nop 0
    v_add_f32_dpp v108, v108, v108 row_ror:2 row_mask:0xf bank_mask:0xf
    v_add_f32_dpp v110, v110, v110 row_ror:2 row_mask:0xf bank_mask:0xf
    s_nop 0
    v_add_f32_dpp v108, v108, v108 row_ror:1 row_mask:0xf bank_mask:0xf
    v_add_f32_dpp v110, v110, v110 row_ror:1 row_mask:0xf bank_mask:0xf
    s_mov_b32 exec_lo, 0x00010001
    s_mov_b32 exec_hi, 0x00010001
    ds_write2_b32 v90, v108, v110 offset0:0 offset1:8
    s_mov_b64 exec, -1
    s_waitcnt lgkmcnt(0)
    s_barrier
L_final:
    ds_read_b128 v[104:107], v91
    ds_read_b128 v[108:111], v91 offset:64
    s_waitcnt lgkmcnt(1)
    v_pk_add_f32 v[104:105], v[104:105], v[106:107]
    s_waitcnt lgkmcnt(0)
    v_pk_add_f32 v[108:109], v[108:109], v[110:111]
    v_add_f32 v104, v104, v105
    v_add_f32 v108, v108, v109
    v_mul_f32 v104, s17, v104
    v_mul_f32 v108, s17, v108
    v_fma_f32 v108, -v104, v104, v108
    v_add_f32 v104, v104, v87
    v_max_f32 v108, 0, v108
    v_add_f32 v108, v108, v86
    v_rsq_f32 v108, v108
    v_sub_f32_dpp v92, v104, v92 quad_perm:[0,0,0,0] row_mask:0xf bank_mask:0xf
    v_sub_f32_dpp v93, v104, v93 quad_perm:[1,1,1,1] row_mask:0xf bank_mask:0xf
    v_sub_f32_dpp v94, v104, v94 quad_perm:[2,2,2,2] row_mask:0xf bank_mask:0xf
    v_sub_f32_dpp v95, v104, v95 quad_perm:[3,3,3,3] row_mask:0xf bank_mask:0xf
    v_mul_f32 v108, v108, v88
    v_mov_b32_dpp v116, v89 quad_perm:[0,0,0,0] row_mask:0xf bank_mask:0xf
    v_mov_b32_dpp v117, v89 quad_perm:[1,1,1,1] row_mask:0xf bank_mask:0xf
    v_mov_b32_dpp v118, v89 quad_perm:[2,2,2,2] row_mask:0xf bank_mask:0xf
    v_mov_b32_dpp v119, v89 quad_perm:[3,3,3,3] row_mask:0xf bank_mask:0xf
    v_mov_b32_dpp v112, v108 quad_perm:[0,0,0,0] row_mask:0xf bank_mask:0xf
    v_mov_b32_dpp v113, v108 quad_perm:[1,1,1,1] row_mask:0xf bank_mask:0xf
    v_mov_b32_dpp v114, v108 quad_perm:[2,2,2,2] row_mask:0xf bank_mask:0xf
    v_mov_b32_dpp v115, v108 quad_perm:[3,3,3,3] row_mask:0xf bank_mask:0xf
    v_pk_fma_f32 v[92:93], v[92:93], v[112:113], v[116:117] neg_lo:[1,0,0] neg_hi:[1,0,0]
    v_pk_fma_f32 v[94:95], v[94:95], v[114:115], v[118:119] neg_lo:[1,0,0] neg_hi:[1,0,0]
    v_pk_mul_f32 v[104:105], v[92:93], v[92:93]
    v_pk_mul_f32 v[106:107], v[94:95], v[94:95]
    v_pk_fma_f32 v[104:105], v[104:105], v[82:83], v[84:85]
    v_pk_fma_f32 v[106:107], v[106:107], v[82:83], v[84:85]
    v_pk_mul_f32 v[104:105], v[104:105], v[92:93]
    v_pk_mul_f32 v[106:107], v[106:107], v[94:95]
    v_exp_f32 v104, v104
    v_exp_f32 v105, v105
    v_exp_f32 v106, v106
    v_exp_f32 v107, v107
    v_add_f32 v104, 1.0, v104
    v_add_f32 v105, 1.0, v105
    v_add_f32 v106, 1.0, v106
    v_add_f32 v107, 1.0, v107
    v_rcp_f32 v104, v104
    v_rcp_f32 v105, v105
    v_rcp_f32 v106, v106
    v_rcp_f32 v107, v107
    s_mov_b64 exec, s[88:89]
    v_pk_mul_f32 v[92:93], v[92:93], v[104:105]
    v_pk_mul_f32 v[94:95], v[94:95], v[106:107]
    v_cvt_pk_bf16_f32 v108, v92, v93
    v_cvt_pk_bf16_f32 v109, v94, v95
    buffer_store_dwordx2 v[108:109], v72, s[32:35], s18 offen
L_done:
    s_endpgm
L_padE:
    s_branch L_hopped
L_end:
.section .rodata,"a"
.p2align 6
.amdhsa_kernel standalone__self_sup_conv_stem_hubert__speech_kernel
  .amdhsa_next_free_vgpr 224
  .amdhsa_next_free_sgpr 102
  .amdhsa_accum_offset 224
  .amdhsa_group_segment_fixed_size 0
  .amdhsa_kernarg_size 64
  .amdhsa_user_sgpr_count 2
  .amdhsa_user_sgpr_kernarg_segment_ptr 1
  .amdhsa_system_sgpr_workgroup_id_x 1
  .amdhsa_float_denorm_mode_32 3
.end_amdhsa_kernel
```
